```python
import torch

def _softmax(x, axis=-1):
    return torch.softmax(x, dim=axis)
def _gelu(x):
    return torch.nn.functional.gelu(x, approximate="tanh")
def _silu(x):
    return torch.nn.functional.silu(x)
def _sigmoid(x):
    return torch.sigmoid(x)
def _layernorm(x, axis=-1, eps=1e-5):
    m = x.mean(dim=axis, keepdim=True)
    v = x.var(dim=axis, keepdim=True, unbiased=False)
    return (x - m) / torch.sqrt(v + eps)
def _scatter_add(tgt, idx, src, axis=0):
    return tgt.clone().index_add_(axis, idx, src)
def _segment_sum(src, seg, n):
    out = torch.zeros((n,) + src.shape[1:], dtype=src.dtype)
    return out.index_add_(0, seg, src)
def _pad(x, pw):
    flat = tuple(v for pair in reversed(pw) for v in pair)
    return torch.nn.functional.pad(x, flat)

kernel_name = 'concat_heads__gqa_block_cached__gqa_block_cached__near_ridge'

def setup_inputs():

    _w = (lambda a: (lambda t: t.to(torch.bfloat16) if t.is_floating_point() else t)(torch.as_tensor(a)))
    def _A_setup():
        B, Sq, D = 16, 96, 640
        Hq, Hkv, Sk, Dh = 32, 32, 512, 192
        assert Hq % Hkv == 0, (Hq, Hkv)
        return {
            "x": _w((lambda *s: torch.randn(*s, dtype=torch.bfloat16) * 0.8)(B, Sq, D)),
            "k_cache": _w((lambda *s: torch.randn(*s, dtype=torch.bfloat16) * 0.8)(B, Hkv, Sk, Dh)),
            "v_cache": _w((lambda *s: torch.randn(*s, dtype=torch.bfloat16) * 0.05)(B, Hkv, Sk, Dh)),
            "wq": _w((lambda *s: torch.randn(*s, dtype=torch.bfloat16) * 0.8)(D, Hq * Dh) * (D ** -0.5)),
            "wo": _w((lambda *s: torch.randn(*s, dtype=torch.bfloat16) * 0.05)(Hq * Dh, D) * ((Hq * Dh) ** -0.5)),
        }
    _A_in = _A_setup()

    def _B_setup():
        B, Sq, D = 16, 96, 640
        Hq, Hkv, Sk, Dh = 32, 32, 512, 192
        assert Hq % Hkv == 0, (Hq, Hkv)
        return {
            "x": _w((lambda *s: torch.randn(*s, dtype=torch.bfloat16) * 0.8)(B, Sq, D)),
            "k_cache": _w((lambda *s: torch.randn(*s, dtype=torch.bfloat16) * 0.8)(B, Hkv, Sk, Dh)),
            "v_cache": _w((lambda *s: torch.randn(*s, dtype=torch.bfloat16) * 0.05)(B, Hkv, Sk, Dh)),
            "wq": _w((lambda *s: torch.randn(*s, dtype=torch.bfloat16) * 0.8)(D, Hq * Dh) * (D ** -0.5)),
            "wo": _w((lambda *s: torch.randn(*s, dtype=torch.bfloat16) * 0.05)(Hq * Dh, D) * ((Hq * Dh) ** -0.5)),
        }
    _B_in = _B_setup()

    return {
        "A_x": _A_in["x"],
        "A_k_cache": _A_in["k_cache"],
        "A_v_cache": _A_in["v_cache"],
        "A_wq": _A_in["wq"],
        "A_wo": _A_in["wo"],
        "B_x": _B_in["x"],
        "B_k_cache": _B_in["k_cache"],
        "B_v_cache": _B_in["v_cache"],
        "B_wq": _B_in["wq"],
        "B_wo": _B_in["wo"],
    }

def reference(A_x, A_k_cache, A_v_cache, A_wq, A_wo, B_x, B_k_cache, B_v_cache, B_wq, B_wo):
    def _A_ref(x, k_cache, v_cache, wq, wo):
        B, Sq, D = x.shape
        Hq, Dh = 32, 192
        Hkv = k_cache.shape[1]
        rep = Hq // Hkv
        q = (lambda x, *d: x.permute(*d))((x @ wq).reshape(B, Sq, Hq, Dh), 0, 2, 1, 3)
        k = (lambda x, n, axis: torch.repeat_interleave(x, n, dim=axis))(k_cache, rep, axis=1)
        v = (lambda x, n, axis: torch.repeat_interleave(x, n, dim=axis))(v_cache, rep, axis=1)
        scores = torch.einsum("bhqd,bhkd->bhqk", q, k) * (Dh ** -0.5)
        p = _softmax(scores, axis=-1)
        o = torch.einsum("bhqk,bhkd->bhqd", p, v)
        return (lambda x, *d: x.permute(*d))(o, 0, 2, 1, 3).reshape(B, Sq, Hq * Dh) @ wo

    def _B_ref(x, k_cache, v_cache, wq, wo):
        B, Sq, D = x.shape
        Hq, Dh = 32, 192
        Hkv = k_cache.shape[1]
        rep = Hq // Hkv
        q = (lambda x, *d: x.permute(*d))((x @ wq).reshape(B, Sq, Hq, Dh), 0, 2, 1, 3)
        k = (lambda x, n, axis: torch.repeat_interleave(x, n, dim=axis))(k_cache, rep, axis=1)
        v = (lambda x, n, axis: torch.repeat_interleave(x, n, dim=axis))(v_cache, rep, axis=1)
        scores = torch.einsum("bhqd,bhkd->bhqk", q, k) * (Dh ** -0.5)
        p = _softmax(scores, axis=-1)
        o = torch.einsum("bhqk,bhkd->bhqd", p, v)
        return (lambda x, *d: x.permute(*d))(o, 0, 2, 1, 3).reshape(B, Sq, Hq * Dh) @ wo

    a = _A_ref(A_x, A_k_cache, A_v_cache, A_wq, A_wo)
    b = _B_ref(B_x, B_k_cache, B_v_cache, B_wq, B_wo)
    return torch.concatenate([a, b], axis=-1)
```

```asm
; @launch kernel=concat_heads__gqa_block_cached__gqa_block_cached__near_ridge_kernel grid=(256,1,1) block=(512,1,1) lds=163840
; @launch kernel=reduce_kernel grid=(768,1,1) block=(320,1,1) lds=0
.amdgcn_target "amdgcn-amd-amdhsa--gfx950"
.text
.globl concat_heads__gqa_block_cached__gqa_block_cached__near_ridge_kernel
.p2align 8
.type concat_heads__gqa_block_cached__gqa_block_cached__near_ridge_kernel,@function
concat_heads__gqa_block_cached__gqa_block_cached__near_ridge_kernel:
    s_cmp_ge_u32 s2, 256
    s_cbranch_scc1 L_end
    s_load_dwordx16 s[64:79], s[0:1], 0
    s_load_dwordx4 s[80:83], s[0:1], 64
    s_load_dwordx2 s[88:89], s[0:1], 96
    s_getpc_b64 s[90:91]
L_pc0:
    s_lshr_b32 s41, s2, 3
    s_mul_i32 s41, s41, 10
    v_add_u32 v1, s41, v0
    v_lshlrev_b32 v1, 7, v1
    v_min_u32 v1, L_codeend-L_pc0-4, v1
    v_cmp_gt_u32 vcc, 10, v0
    s_nop 0
    s_and_saveexec_b64 s[92:93], vcc
    s_cbranch_execz L_nopf
    global_load_dword v101, v1, s[90:91]
L_nopf:
    s_mov_b64 exec, s[92:93]
    v_lshrrev_b32 v1, 6, v0
    v_and_b32 v255, 63, v0
    s_and_b32 s40, s2, 7
    v_readfirstlane_b32 s3, v1
    s_lshr_b32 s41, s2, 3
    s_lshr_b32 s38, s40, 2
    s_and_b32 s50, s40, 3
    s_lshr_b32 s51, s41, 4
    s_lshl_b32 s36, s50, 3
    s_add_u32 s36, s36, s51
    s_and_b32 s37, s41, 15
    s_lshl_b32 s39, s51, 2
    s_add_u32 s39, s39, s50
    s_mov_b32 s6, 100663296
    s_mov_b32 s7, 0x20000
    s_mov_b32 s10, 100663296
    s_mov_b32 s11, 0x20000
    s_mov_b32 s14, 7864320
    s_mov_b32 s15, 0x20000
    s_mov_b32 s18, 7864320
    s_mov_b32 s19, 0x20000
    s_mov_b32 s22, 1966080
    s_mov_b32 s23, 0x20000
    s_mov_b32 s26, 438042624
    s_mov_b32 s27, 0x20000
    s_lshr_b32 s53, s41, 4
    s_mul_i32 s53, s53, 48
    v_min_u32 v5, 47, v255
    v_add_u32 v1, s53, v5
    v_mul_u32_u24 v108, 1280, v1
    s_mul_i32 s60, s37, 122880
    s_lshl_b32 s52, s3, 9
    s_add_u32 s60, s60, s52
    s_mul_i32 s53, s3, 48
    v_add_u32 v1, s53, v5
    v_min_u32 v1, 119, v1
    s_lshl_b32 s52, s37, 2
    s_mul_i32 s61, s36, 384
    v_mul_u32_u24 v2, 171, v1
    v_lshrrev_b32 v2, 9, v2
    v_mul_u32_u24 v3, 3, v2
    v_sub_u32 v3, v1, v3
    v_lshrrev_b32 v4, 2, v2
    v_and_b32 v2, 3, v2
    v_lshl_add_u32 v2, v4, 6, v2
    v_add_u32 v2, s52, v2
    v_mul_u32_u24 v2, 12288, v2
    v_lshl_add_u32 v107, v3, 7, v2
    s_waitcnt lgkmcnt(0)
    s_cmp_eq_u32 s38, 0
    s_cselect_b32 s20, s64, s74
    s_cselect_b32 s21, s65, s75
    s_cselect_b32 s12, s70, s80
    s_cselect_b32 s13, s71, s81
    s_cmp_lg_u32 s3, 0
    s_cbranch_scc1 A_tr0
    buffer_load_dword v100, v108, s[20:23], s60 offen
    buffer_load_dword v100, v107, s[12:15], s61 offen
    buffer_load_dword v100, v108, s[20:23], s60 offen offset:128
    buffer_load_dword v100, v108, s[20:23], s60 offen offset:256
    buffer_load_dword v100, v108, s[20:23], s60 offen offset:384
A_tr0:
    s_cmp_eq_u32 s38, 0
    s_cselect_b32 s4, s66, s76
    s_cselect_b32 s5, s67, s77
    s_cselect_b32 s8, s68, s78
    s_cselect_b32 s9, s69, s79
    s_cselect_b32 s16, s72, s82
    s_cselect_b32 s17, s73, s83
    s_mov_b32 s24, s88
    s_mov_b32 s25, s89
    s_cmp_eq_u32 s3, 3
    s_cbranch_scc1 L_loader
    s_cmp_ge_u32 s3, 4
    s_cbranch_scc1 L_proj
    v_min_u32 v1, 59, v255
    v_mul_u32_u24 v2, 171, v1
    v_lshrrev_b32 v2, 9, v2
    v_mul_u32_u24 v3, 3, v2
    v_sub_u32 v3, v1, v3
    v_lshrrev_b32 v4, 2, v2
    v_and_b32 v2, 3, v2
    v_lshl_add_u32 v2, v4, 6, v2
    v_add_u32 v2, s52, v2
    v_mul_u32_u24 v2, 12288, v2
    v_lshl_add_u32 v109, v3, 7, v2
    s_cmp_eq_u32 s3, 1
    s_cselect_b32 s63, 0, 3
    s_cmp_eq_u32 s3, 0
    s_cselect_b32 s63, 100, s63
    s_setprio 2
    s_mov_b32 s47, 0x44002000
    s_mov_b32 s45, 24576
    s_mov_b32 s48, 0
    s_lshl_b32 s52, s3, 11
    v_lshlrev_b32 v249, 4, v255
    v_add_u32 v249, s52, v249
    v_add_u32 v248, 73728, v249
    v_and_b32 v1, 15, v255
    v_lshrrev_b32 v2, 4, v255
    v_mul_u32_u24 v3, 384, v1
    v_and_b32 v4, 6, v1
    v_xor_b32 v5, v2, v4
    v_lshl_add_u32 v224, v5, 4, v3
    v_xor_b32 v225, 64, v224
    v_lshrrev_b32 v5, 2, v255
    v_mul_u32_u24 v6, 384, v5
    v_and_b32 v7, 1, v255
    v_lshl_add_u32 v6, v7, 3, v6
    v_and_b32 v5, 6, v5
    v_bfe_u32 v7, v255, 1, 1
    v_xor_b32 v5, v5, v7
    v_lshl_add_u32 v6, v5, 4, v6
    v_add_u32 v226, 12288, v6
    v_xor_b32 v227, 32, v226
    v_xor_b32 v228, 64, v226
    v_xor_b32 v229, 96, v226
    v_mov_b32 v232, 0
    v_mov_b32 v233, 0
    v_mov_b32 v234, 0
    v_mov_b32 v235, 0
    v_mov_b32 v236, 0
    v_mov_b32 v237, 0
    v_mov_b32 v238, 0
    v_mov_b32 v239, 0
    s_mov_b32 s55, 0
A_idle:
    s_barrier
    s_cmp_eq_u32 s55, s63
    s_cbranch_scc1 A_touch
A_tr1:
    s_add_u32 s55, s55, 1
    s_cmp_lt_u32 s55, 10
    s_cbranch_scc1 A_idle
    s_waitcnt vmcnt(0)
    s_barrier
    ds_read_b128 v[184:187], v224 offset:0
    ds_read_b128 v[96:99], v248 offset:0
    ds_read_b128 v[188:191], v224 offset:6144
    ds_read_b128 v[120:123], v248 offset:1024
    ds_read_b128 v[192:195], v225 offset:0
    ds_read_b128 v[100:103], v248 offset:6144
    ds_read_b128 v[196:199], v225 offset:6144
    ds_read_b128 v[124:127], v248 offset:7168
    ds_read_b128 v[168:171], v224 offset:128
    ds_read_b128 v[104:107], v248 offset:12288
    ds_read_b128 v[172:175], v224 offset:6272
    ds_read_b128 v[128:131], v248 offset:13312
    s_add_u32 s48, s48, 1
    s_cmp_eq_u32 s48, 3
    s_cselect_b32 s48, 0, s48
    s_cselect_b32 s49, 4294918144, s45
    s_waitcnt lgkmcnt(10)
    v_mfma_f32_16x16x32_bf16 v[144:147], v[184:187], v[96:99], v[232:235]
    s_waitcnt lgkmcnt(8)
    v_mfma_f32_16x16x32_bf16 v[152:155], v[184:187], v[120:123], v[236:239]
    ds_read_b128 v[176:179], v225 offset:128
    ds_read_b128 v[108:111], v248 offset:18432
    v_mfma_f32_16x16x32_bf16 v[156:159], v[188:191], v[120:123], v[236:239]
    v_mfma_f32_16x16x32_bf16 v[148:151], v[188:191], v[96:99], v[232:235]
    ds_read_b128 v[180:183], v225 offset:6272
    ds_read_b128 v[132:135], v248 offset:19456
    s_waitcnt lgkmcnt(10)
    v_mfma_f32_16x16x32_bf16 v[144:147], v[192:195], v[100:103], v[144:147]
    s_waitcnt lgkmcnt(8)
    v_mfma_f32_16x16x32_bf16 v[152:155], v[192:195], v[124:127], v[152:155]
    ds_read_b128 v[184:187], v224 offset:256
    ds_read_b128 v[112:115], v248 offset:24576
    v_mfma_f32_16x16x32_bf16 v[156:159], v[196:199], v[124:127], v[156:159]
    v_mfma_f32_16x16x32_bf16 v[148:151], v[196:199], v[100:103], v[148:151]
    ds_read_b128 v[188:191], v224 offset:6400
    ds_read_b128 v[136:139], v248 offset:25600
    s_waitcnt lgkmcnt(10)
    v_mfma_f32_16x16x32_bf16 v[144:147], v[168:171], v[104:107], v[144:147]
    s_waitcnt lgkmcnt(8)
    v_mfma_f32_16x16x32_bf16 v[152:155], v[168:171], v[128:131], v[152:155]
    ds_read_b128 v[192:195], v225 offset:256
    ds_read_b128 v[116:119], v248 offset:30720
    v_mfma_f32_16x16x32_bf16 v[156:159], v[172:175], v[128:131], v[156:159]
    v_mfma_f32_16x16x32_bf16 v[148:151], v[172:175], v[104:107], v[148:151]
    ds_read_b128 v[196:199], v225 offset:6400
    ds_read_b128 v[140:143], v248 offset:31744
    s_waitcnt lgkmcnt(10)
    v_mfma_f32_16x16x32_bf16 v[144:147], v[176:179], v[108:111], v[144:147]
    s_waitcnt lgkmcnt(8)
    v_mfma_f32_16x16x32_bf16 v[152:155], v[176:179], v[132:135], v[152:155]
    v_mfma_f32_16x16x32_bf16 v[156:159], v[180:183], v[132:135], v[156:159]
    v_mfma_f32_16x16x32_bf16 v[148:151], v[180:183], v[108:111], v[148:151]
    s_waitcnt lgkmcnt(6)
    v_mfma_f32_16x16x32_bf16 v[144:147], v[184:187], v[112:115], v[144:147]
    s_waitcnt lgkmcnt(4)
    v_mfma_f32_16x16x32_bf16 v[152:155], v[184:187], v[136:139], v[152:155]
    v_mfma_f32_16x16x32_bf16 v[156:159], v[188:191], v[136:139], v[156:159]
    v_mfma_f32_16x16x32_bf16 v[148:151], v[188:191], v[112:115], v[148:151]
    s_waitcnt lgkmcnt(2)
    v_mfma_f32_16x16x32_bf16 v[144:147], v[192:195], v[116:119], v[144:147]
    s_waitcnt lgkmcnt(0)
    v_mfma_f32_16x16x32_bf16 v[152:155], v[192:195], v[140:143], v[152:155]
    v_mfma_f32_16x16x32_bf16 v[156:159], v[196:199], v[140:143], v[156:159]
    v_mfma_f32_16x16x32_bf16 v[148:151], v[196:199], v[116:119], v[148:151]
    v_add_u32 v224, s49, v224
    v_add_u32 v225, s49, v225
    v_add_u32 v226, s49, v226
    v_add_u32 v227, s49, v227
    v_add_u32 v228, s49, v228
    v_add_u32 v229, s49, v229
    s_mov_b32 s56, 0
    s_mov_b32 s58, 0
A_unit:
    s_mov_b32 s55, 1
    s_barrier
    ds_read_b64_tr_b16 v[168:169], v226 offset:0
    ds_read_b64_tr_b16 v[170:171], v226 offset:6144
    ds_read_b64_tr_b16 v[172:173], v227 offset:0
    ds_read_b64_tr_b16 v[174:175], v227 offset:6144
    ds_read_b128 v[176:179], v224 offset:0
    ds_read_b128 v[180:183], v224 offset:6144
    ds_read_b64_tr_b16 v[184:185], v228 offset:0
    ds_read_b64_tr_b16 v[186:187], v228 offset:6144
    ds_read_b64_tr_b16 v[188:189], v229 offset:0
    ds_read_b64_tr_b16 v[190:191], v229 offset:6144
    ds_read_b128 v[192:195], v225 offset:0
    ds_read_b128 v[196:199], v225 offset:6144
    s_add_u32 s48, s48, 1
    s_cmp_eq_u32 s48, 3
    s_cselect_b32 s48, 0, s48
    s_cselect_b32 s49, 4294918144, s45
    v_max3_f32 v250, v144, v145, v146
    v_max3_f32 v251, v152, v153, v154
    v_max3_f32 v250, v250, v147, v148
    v_max3_f32 v251, v251, v155, v156
    v_max3_f32 v250, v250, v149, v150
    v_max3_f32 v251, v251, v157, v158
    v_max_f32 v250, v250, v151
    v_max_f32 v251, v251, v159
    v_mov_b32 v240, v250
    v_mov_b32 v242, v251
    v_mov_b32 v241, v250
    v_mov_b32 v243, v251
    s_nop 0
    v_permlane32_swap_b32 v240, v241
    s_nop 0
    v_permlane32_swap_b32 v242, v243
    v_max_f32 v240, v240, v241
    v_max_f32 v242, v242, v243
    v_mov_b32 v241, v240
    v_mov_b32 v243, v242
    s_nop 0
    v_permlane16_swap_b32 v240, v241
    s_nop 0
    v_permlane16_swap_b32 v242, v243
    v_max_f32 v240, v240, v241
    v_max_f32 v242, v242, v243
    v_sub_f32 v144, v144, v240
    v_sub_f32 v145, v145, v240
    v_sub_f32 v146, v146, v240
    v_sub_f32 v147, v147, v240
    v_sub_f32 v148, v148, v240
    v_sub_f32 v149, v149, v240
    v_sub_f32 v150, v150, v240
    v_sub_f32 v151, v151, v240
    v_sub_f32 v232, 0, v240
    v_sub_f32 v233, 0, v240
    v_sub_f32 v234, 0, v240
    v_sub_f32 v235, 0, v240
    v_sub_f32 v152, v152, v242
    v_sub_f32 v153, v153, v242
    v_sub_f32 v154, v154, v242
    v_sub_f32 v155, v155, v242
    v_sub_f32 v156, v156, v242
    v_sub_f32 v157, v157, v242
    v_sub_f32 v158, v158, v242
    v_sub_f32 v159, v159, v242
    v_sub_f32 v236, 0, v242
    v_sub_f32 v237, 0, v242
    v_sub_f32 v238, 0, v242
    v_sub_f32 v239, 0, v242
    v_exp_f32 v200, v144
    v_exp_f32 v201, v145
    v_exp_f32 v202, v146
    v_exp_f32 v203, v147
    v_exp_f32 v204, v148
    v_pk_add_f32 v[216:217], v[200:201], v[202:203]
    v_exp_f32 v205, v149
    v_cvt_pk_bf16_f32 v160, v200, v201
    v_exp_f32 v206, v150
    v_cvt_pk_bf16_f32 v161, v202, v203
    v_exp_f32 v207, v151
    v_exp_f32 v208, v152
    v_pk_add_f32 v[218:219], v[204:205], v[206:207]
    v_exp_f32 v209, v153
    v_cvt_pk_bf16_f32 v162, v204, v205
    v_exp_f32 v210, v154
    v_pk_add_f32 v[216:217], v[216:217], v[218:219]
    v_exp_f32 v211, v155
    v_cvt_pk_bf16_f32 v163, v206, v207
    v_exp_f32 v212, v156
    v_pk_add_f32 v[220:221], v[208:209], v[210:211]
    v_add_f32 v250, v216, v217
    v_exp_f32 v213, v157
    v_cvt_pk_bf16_f32 v164, v208, v209
    v_exp_f32 v214, v158
    v_cvt_pk_bf16_f32 v165, v210, v211
    v_exp_f32 v215, v159
    s_nop 0
    v_pk_add_f32 v[222:223], v[212:213], v[214:215]
    v_cvt_pk_bf16_f32 v166, v212, v213
    v_pk_add_f32 v[220:221], v[220:221], v[222:223]
    v_cvt_pk_bf16_f32 v167, v214, v215
    v_add_f32 v251, v220, v221
    s_setprio 0
    ds_read_b64_tr_b16 v[200:201], v226 offset:128
    ds_read_b64_tr_b16 v[202:203], v226 offset:6272
    ds_read_b64_tr_b16 v[204:205], v227 offset:128
    s_waitcnt lgkmcnt(14)
    ds_read_b64_tr_b16 v[206:207], v227 offset:6272
    s_waitcnt lgkmcnt(14)
    v_mfma_f32_16x16x32_bf16 v[0:3], v[168:171], v[160:163], 0
    ds_read_b128 v[208:211], v224 offset:128
    v_mfma_f32_16x16x32_bf16 v[4:7], v[168:171], v[164:167], 0
    v_mov_b32 v230, v250
    s_waitcnt lgkmcnt(13)
    v_mfma_f32_16x16x32_bf16 v[12:15], v[172:175], v[164:167], 0
    ds_read_b128 v[212:215], v224 offset:6272
    v_mfma_f32_16x16x32_bf16 v[8:11], v[172:175], v[160:163], 0
    v_mov_b32 v231, v251
    s_waitcnt lgkmcnt(13)
    v_mfma_f32_16x16x32_bf16 v[144:147], v[176:179], v[96:99], v[232:235]
    ds_read_b64_tr_b16 v[168:169], v228 offset:128
    v_mfma_f32_16x16x32_bf16 v[152:155], v[176:179], v[120:123], v[236:239]
    ds_read_b64_tr_b16 v[170:171], v228 offset:6272
    s_waitcnt lgkmcnt(14)
    v_mfma_f32_16x16x32_bf16 v[156:159], v[180:183], v[120:123], v[236:239]
    ds_read_b64_tr_b16 v[172:173], v229 offset:128
    v_mfma_f32_16x16x32_bf16 v[148:151], v[180:183], v[96:99], v[232:235]
    s_waitcnt lgkmcnt(14)
    ds_read_b64_tr_b16 v[174:175], v229 offset:6272
    s_waitcnt lgkmcnt(14)
    v_mfma_f32_16x16x32_bf16 v[16:19], v[184:187], v[160:163], 0
    ds_read_b128 v[176:179], v225 offset:128
    v_mfma_f32_16x16x32_bf16 v[20:23], v[184:187], v[164:167], 0
    s_waitcnt lgkmcnt(13)
    v_mfma_f32_16x16x32_bf16 v[28:31], v[188:191], v[164:167], 0
    ds_read_b128 v[180:183], v225 offset:6272
    v_mfma_f32_16x16x32_bf16 v[24:27], v[188:191], v[160:163], 0
    s_waitcnt lgkmcnt(13)
    v_mfma_f32_16x16x32_bf16 v[144:147], v[192:195], v[100:103], v[144:147]
    ds_read_b64_tr_b16 v[184:185], v226 offset:256
    v_mfma_f32_16x16x32_bf16 v[152:155], v[192:195], v[124:127], v[152:155]
    ds_read_b64_tr_b16 v[186:187], v226 offset:6400
    s_waitcnt lgkmcnt(14)
    v_mfma_f32_16x16x32_bf16 v[156:159], v[196:199], v[124:127], v[156:159]
    ds_read_b64_tr_b16 v[188:189], v227 offset:256
    v_mfma_f32_16x16x32_bf16 v[148:151], v[196:199], v[100:103], v[148:151]
    s_waitcnt lgkmcnt(14)
    ds_read_b64_tr_b16 v[190:191], v227 offset:6400
    s_waitcnt lgkmcnt(14)
    v_mfma_f32_16x16x32_bf16 v[32:35], v[200:203], v[160:163], 0
    ds_read_b128 v[192:195], v224 offset:256
    v_mfma_f32_16x16x32_bf16 v[36:39], v[200:203], v[164:167], 0
    s_waitcnt lgkmcnt(13)
    v_mfma_f32_16x16x32_bf16 v[44:47], v[204:207], v[164:167], 0
    ds_read_b128 v[196:199], v224 offset:6400
    v_mfma_f32_16x16x32_bf16 v[40:43], v[204:207], v[160:163], 0
    s_waitcnt lgkmcnt(13)
    v_mfma_f32_16x16x32_bf16 v[144:147], v[208:211], v[104:107], v[144:147]
    ds_read_b64_tr_b16 v[200:201], v228 offset:256
    v_mfma_f32_16x16x32_bf16 v[152:155], v[208:211], v[128:131], v[152:155]
    ds_read_b64_tr_b16 v[202:203], v228 offset:6400
    s_waitcnt lgkmcnt(14)
    v_mfma_f32_16x16x32_bf16 v[156:159], v[212:215], v[128:131], v[156:159]
    ds_read_b64_tr_b16 v[204:205], v229 offset:256
    v_mfma_f32_16x16x32_bf16 v[148:151], v[212:215], v[104:107], v[148:151]
    s_waitcnt lgkmcnt(14)
    ds_read_b64_tr_b16 v[206:207], v229 offset:6400
    s_waitcnt lgkmcnt(14)
    v_mfma_f32_16x16x32_bf16 v[48:51], v[168:171], v[160:163], 0
    ds_read_b128 v[208:211], v225 offset:256
    v_mfma_f32_16x16x32_bf16 v[52:55], v[168:171], v[164:167], 0
    s_waitcnt lgkmcnt(13)
    v_mfma_f32_16x16x32_bf16 v[60:63], v[172:175], v[164:167], 0
    ds_read_b128 v[212:215], v225 offset:6400
    v_mfma_f32_16x16x32_bf16 v[56:59], v[172:175], v[160:163], 0
    s_waitcnt lgkmcnt(13)
    v_mfma_f32_16x16x32_bf16 v[144:147], v[176:179], v[108:111], v[144:147]
    v_mfma_f32_16x16x32_bf16 v[152:155], v[176:179], v[132:135], v[152:155]
    v_add_u32 v224, s49, v224
    s_waitcnt lgkmcnt(12)
    v_mfma_f32_16x16x32_bf16 v[156:159], v[180:183], v[132:135], v[156:159]
    v_mfma_f32_16x16x32_bf16 v[148:151], v[180:183], v[108:111], v[148:151]
    v_add_u32 v225, s49, v225
    s_waitcnt lgkmcnt(10)
    v_mfma_f32_16x16x32_bf16 v[64:67], v[184:187], v[160:163], 0
    v_mfma_f32_16x16x32_bf16 v[68:71], v[184:187], v[164:167], 0
    v_add_u32 v226, s49, v226
    s_waitcnt lgkmcnt(8)
    v_mfma_f32_16x16x32_bf16 v[76:79], v[188:191], v[164:167], 0
    v_mfma_f32_16x16x32_bf16 v[72:75], v[188:191], v[160:163], 0
    v_add_u32 v227, s49, v227
    s_waitcnt lgkmcnt(7)
    v_mfma_f32_16x16x32_bf16 v[144:147], v[192:195], v[112:115], v[144:147]
    v_mfma_f32_16x16x32_bf16 v[152:155], v[192:195], v[136:139], v[152:155]
    v_add_u32 v228, s49, v228
    s_waitcnt lgkmcnt(6)
    v_mfma_f32_16x16x32_bf16 v[156:159], v[196:199], v[136:139], v[156:159]
    v_mfma_f32_16x16x32_bf16 v[148:151], v[196:199], v[112:115], v[148:151]
    v_add_u32 v229, s49, v229
    s_waitcnt lgkmcnt(4)
    v_mfma_f32_16x16x32_bf16 v[80:83], v[200:203], v[160:163], 0
    v_mfma_f32_16x16x32_bf16 v[84:87], v[200:203], v[164:167], 0
    s_waitcnt lgkmcnt(2)
    v_mfma_f32_16x16x32_bf16 v[92:95], v[204:207], v[164:167], 0
    v_mfma_f32_16x16x32_bf16 v[88:91], v[204:207], v[160:163], 0
    s_waitcnt lgkmcnt(1)
    v_mfma_f32_16x16x32_bf16 v[144:147], v[208:211], v[116:119], v[144:147]
    v_mfma_f32_16x16x32_bf16 v[152:155], v[208:211], v[140:143], v[152:155]
    s_waitcnt lgkmcnt(0)
    v_mfma_f32_16x16x32_bf16 v[156:159], v[212:215], v[140:143], v[156:159]
    v_mfma_f32_16x16x32_bf16 v[148:151], v[212:215], v[116:119], v[148:151]
A_loop:
    s_barrier
    ds_read_b64_tr_b16 v[168:169], v226 offset:0
    ds_read_b64_tr_b16 v[170:171], v226 offset:6144
    ds_read_b64_tr_b16 v[172:173], v227 offset:0
    ds_read_b64_tr_b16 v[174:175], v227 offset:6144
    ds_read_b128 v[176:179], v224 offset:0
    ds_read_b128 v[180:183], v224 offset:6144
    ds_read_b64_tr_b16 v[184:185], v228 offset:0
    ds_read_b64_tr_b16 v[186:187], v228 offset:6144
    ds_read_b64_tr_b16 v[188:189], v229 offset:0
    ds_read_b64_tr_b16 v[190:191], v229 offset:6144
    ds_read_b128 v[192:195], v225 offset:0
    ds_read_b128 v[196:199], v225 offset:6144
    s_add_u32 s48, s48, 1
    s_cmp_eq_u32 s48, 3
    s_cselect_b32 s48, 0, s48
    s_cselect_b32 s49, 4294918144, s45
A_rare0_ret:
    v_exp_f32 v200, v144
    v_exp_f32 v201, v145
    v_exp_f32 v202, v146
    v_exp_f32 v203, v147
    v_exp_f32 v204, v148
    v_pk_add_f32 v[216:217], v[200:201], v[202:203]
    v_exp_f32 v205, v149
    v_cvt_pk_bf16_f32 v160, v200, v201
    v_exp_f32 v206, v150
    v_cvt_pk_bf16_f32 v161, v202, v203
    v_exp_f32 v207, v151
    v_exp_f32 v208, v152
    v_pk_add_f32 v[218:219], v[204:205], v[206:207]
    v_exp_f32 v209, v153
    v_cvt_pk_bf16_f32 v162, v204, v205
    v_exp_f32 v210, v154
    v_pk_add_f32 v[216:217], v[216:217], v[218:219]
    v_exp_f32 v211, v155
    v_cvt_pk_bf16_f32 v163, v206, v207
    v_exp_f32 v212, v156
    v_pk_add_f32 v[220:221], v[208:209], v[210:211]
    v_add_f32 v250, v216, v217
    v_exp_f32 v213, v157
    v_cvt_pk_bf16_f32 v164, v208, v209
    v_exp_f32 v214, v158
    v_cvt_pk_bf16_f32 v165, v210, v211
    v_exp_f32 v215, v159
    v_cmp_lt_f32 vcc, s47, v250
    v_pk_add_f32 v[222:223], v[212:213], v[214:215]
    v_cvt_pk_bf16_f32 v166, v212, v213
    v_pk_add_f32 v[220:221], v[220:221], v[222:223]
    v_cvt_pk_bf16_f32 v167, v214, v215
    v_add_f32 v251, v220, v221
    v_cmp_lt_f32 s[60:61], s47, v251
    s_nop 0
    s_or_b64 s[60:61], s[60:61], vcc
    s_cbranch_scc1 A_rare0
    ds_read_b64_tr_b16 v[200:201], v226 offset:128
    ds_read_b64_tr_b16 v[202:203], v226 offset:6272
    ds_read_b64_tr_b16 v[204:205], v227 offset:128
    s_waitcnt lgkmcnt(14)
    ds_read_b64_tr_b16 v[206:207], v227 offset:6272
    s_waitcnt lgkmcnt(14)
    v_mfma_f32_16x16x32_bf16 v[0:3], v[168:171], v[160:163], v[0:3]
    ds_read_b128 v[208:211], v224 offset:128
    v_mfma_f32_16x16x32_bf16 v[4:7], v[168:171], v[164:167], v[4:7]
    v_add_f32 v230, v230, v250
    s_waitcnt lgkmcnt(13)
    v_mfma_f32_16x16x32_bf16 v[12:15], v[172:175], v[164:167], v[12:15]
    ds_read_b128 v[212:215], v224 offset:6272
    v_mfma_f32_16x16x32_bf16 v[8:11], v[172:175], v[160:163], v[8:11]
    v_add_f32 v231, v231, v251
    s_waitcnt lgkmcnt(13)
    v_mfma_f32_16x16x32_bf16 v[144:147], v[176:179], v[96:99], v[232:235]
    ds_read_b64_tr_b16 v[168:169], v228 offset:128
    v_mfma_f32_16x16x32_bf16 v[152:155], v[176:179], v[120:123], v[236:239]
    ds_read_b64_tr_b16 v[170:171], v228 offset:6272
    s_waitcnt lgkmcnt(14)
    v_mfma_f32_16x16x32_bf16 v[156:159], v[180:183], v[120:123], v[236:239]
    ds_read_b64_tr_b16 v[172:173], v229 offset:128
    v_mfma_f32_16x16x32_bf16 v[148:151], v[180:183], v[96:99], v[232:235]
    s_waitcnt lgkmcnt(14)
    ds_read_b64_tr_b16 v[174:175], v229 offset:6272
    s_waitcnt lgkmcnt(14)
    v_mfma_f32_16x16x32_bf16 v[16:19], v[184:187], v[160:163], v[16:19]
    ds_read_b128 v[176:179], v225 offset:128
    v_mfma_f32_16x16x32_bf16 v[20:23], v[184:187], v[164:167], v[20:23]
    s_waitcnt lgkmcnt(13)
    v_mfma_f32_16x16x32_bf16 v[28:31], v[188:191], v[164:167], v[28:31]
    ds_read_b128 v[180:183], v225 offset:6272
    v_mfma_f32_16x16x32_bf16 v[24:27], v[188:191], v[160:163], v[24:27]
    s_waitcnt lgkmcnt(13)
    v_mfma_f32_16x16x32_bf16 v[144:147], v[192:195], v[100:103], v[144:147]
    ds_read_b64_tr_b16 v[184:185], v226 offset:256
    v_mfma_f32_16x16x32_bf16 v[152:155], v[192:195], v[124:127], v[152:155]
    ds_read_b64_tr_b16 v[186:187], v226 offset:6400
    s_waitcnt lgkmcnt(14)
    v_mfma_f32_16x16x32_bf16 v[156:159], v[196:199], v[124:127], v[156:159]
    ds_read_b64_tr_b16 v[188:189], v227 offset:256
    v_mfma_f32_16x16x32_bf16 v[148:151], v[196:199], v[100:103], v[148:151]
    s_waitcnt lgkmcnt(14)
    ds_read_b64_tr_b16 v[190:191], v227 offset:6400
    s_waitcnt lgkmcnt(14)
    v_mfma_f32_16x16x32_bf16 v[32:35], v[200:203], v[160:163], v[32:35]
    ds_read_b128 v[192:195], v224 offset:256
    v_mfma_f32_16x16x32_bf16 v[36:39], v[200:203], v[164:167], v[36:39]
    s_waitcnt lgkmcnt(13)
    v_mfma_f32_16x16x32_bf16 v[44:47], v[204:207], v[164:167], v[44:47]
    ds_read_b128 v[196:199], v224 offset:6400
    v_mfma_f32_16x16x32_bf16 v[40:43], v[204:207], v[160:163], v[40:43]
    s_waitcnt lgkmcnt(13)
    v_mfma_f32_16x16x32_bf16 v[144:147], v[208:211], v[104:107], v[144:147]
    ds_read_b64_tr_b16 v[200:201], v228 offset:256
    v_mfma_f32_16x16x32_bf16 v[152:155], v[208:211], v[128:131], v[152:155]
    ds_read_b64_tr_b16 v[202:203], v228 offset:6400
    s_waitcnt lgkmcnt(14)
    v_mfma_f32_16x16x32_bf16 v[156:159], v[212:215], v[128:131], v[156:159]
    ds_read_b64_tr_b16 v[204:205], v229 offset:256
    v_mfma_f32_16x16x32_bf16 v[148:151], v[212:215], v[104:107], v[148:151]
    s_waitcnt lgkmcnt(14)
    ds_read_b64_tr_b16 v[206:207], v229 offset:6400
    s_waitcnt lgkmcnt(14)
    v_mfma_f32_16x16x32_bf16 v[48:51], v[168:171], v[160:163], v[48:51]
    ds_read_b128 v[208:211], v225 offset:256
    v_mfma_f32_16x16x32_bf16 v[52:55], v[168:171], v[164:167], v[52:55]
    s_waitcnt lgkmcnt(13)
    v_mfma_f32_16x16x32_bf16 v[60:63], v[172:175], v[164:167], v[60:63]
    ds_read_b128 v[212:215], v225 offset:6400
    v_mfma_f32_16x16x32_bf16 v[56:59], v[172:175], v[160:163], v[56:59]
    s_waitcnt lgkmcnt(13)
    v_mfma_f32_16x16x32_bf16 v[144:147], v[176:179], v[108:111], v[144:147]
    v_mfma_f32_16x16x32_bf16 v[152:155], v[176:179], v[132:135], v[152:155]
    v_add_u32 v224, s49, v224
    s_waitcnt lgkmcnt(12)
    v_mfma_f32_16x16x32_bf16 v[156:159], v[180:183], v[132:135], v[156:159]
    v_mfma_f32_16x16x32_bf16 v[148:151], v[180:183], v[108:111], v[148:151]
    v_add_u32 v225, s49, v225
    s_waitcnt lgkmcnt(10)
    v_mfma_f32_16x16x32_bf16 v[64:67], v[184:187], v[160:163], v[64:67]
    v_mfma_f32_16x16x32_bf16 v[68:71], v[184:187], v[164:167], v[68:71]
    v_add_u32 v226, s49, v226
    s_waitcnt lgkmcnt(8)
    v_mfma_f32_16x16x32_bf16 v[76:79], v[188:191], v[164:167], v[76:79]
    v_mfma_f32_16x16x32_bf16 v[72:75], v[188:191], v[160:163], v[72:75]
    v_add_u32 v227, s49, v227
    s_waitcnt lgkmcnt(7)
    v_mfma_f32_16x16x32_bf16 v[144:147], v[192:195], v[112:115], v[144:147]
    v_mfma_f32_16x16x32_bf16 v[152:155], v[192:195], v[136:139], v[152:155]
    v_add_u32 v228, s49, v228
    s_waitcnt lgkmcnt(6)
    v_mfma_f32_16x16x32_bf16 v[156:159], v[196:199], v[136:139], v[156:159]
    v_mfma_f32_16x16x32_bf16 v[148:151], v[196:199], v[112:115], v[148:151]
    v_add_u32 v229, s49, v229
    s_waitcnt lgkmcnt(4)
    v_mfma_f32_16x16x32_bf16 v[80:83], v[200:203], v[160:163], v[80:83]
    v_mfma_f32_16x16x32_bf16 v[84:87], v[200:203], v[164:167], v[84:87]
    s_waitcnt lgkmcnt(2)
    v_mfma_f32_16x16x32_bf16 v[92:95], v[204:207], v[164:167], v[92:95]
    v_mfma_f32_16x16x32_bf16 v[88:91], v[204:207], v[160:163], v[88:91]
    s_waitcnt lgkmcnt(1)
    v_mfma_f32_16x16x32_bf16 v[144:147], v[208:211], v[116:119], v[144:147]
    v_mfma_f32_16x16x32_bf16 v[152:155], v[208:211], v[140:143], v[152:155]
    s_waitcnt lgkmcnt(0)
    v_mfma_f32_16x16x32_bf16 v[156:159], v[212:215], v[140:143], v[156:159]
    v_mfma_f32_16x16x32_bf16 v[148:151], v[212:215], v[116:119], v[148:151]
    s_add_u32 s55, s55, 1
    s_cmp_lt_u32 s55, 15
    s_cbranch_scc1 A_loop
    s_add_u32 s56, s56, 1
    s_cmp_eq_u32 s56, 4
    s_cbranch_scc1 A_done
    s_setprio 2
    s_barrier
    ds_read_b64_tr_b16 v[168:169], v226 offset:0
    ds_read_b64_tr_b16 v[170:171], v226 offset:6144
    ds_read_b64_tr_b16 v[172:173], v227 offset:0
    ds_read_b64_tr_b16 v[174:175], v227 offset:6144
    ds_read_b64_tr_b16 v[176:177], v228 offset:0
    ds_read_b64_tr_b16 v[178:179], v228 offset:6144
    ds_read_b64_tr_b16 v[180:181], v229 offset:0
    ds_read_b64_tr_b16 v[182:183], v229 offset:6144
    ds_read_b64_tr_b16 v[184:185], v226 offset:128
    ds_read_b64_tr_b16 v[186:187], v226 offset:6272
    ds_read_b64_tr_b16 v[188:189], v227 offset:128
    ds_read_b64_tr_b16 v[190:191], v227 offset:6272
    s_add_u32 s48, s48, 1
    s_cmp_eq_u32 s48, 3
    s_cselect_b32 s48, 0, s48
    s_cselect_b32 s49, 4294918144, s45
A_rare1_ret:
    v_exp_f32 v200, v144
    v_exp_f32 v201, v145
    v_exp_f32 v202, v146
    v_exp_f32 v203, v147
    v_exp_f32 v204, v148
    v_pk_add_f32 v[216:217], v[200:201], v[202:203]
    v_exp_f32 v205, v149
    v_cvt_pk_bf16_f32 v160, v200, v201
    v_exp_f32 v206, v150
    v_cvt_pk_bf16_f32 v161, v202, v203
    v_exp_f32 v207, v151
    v_exp_f32 v208, v152
    v_pk_add_f32 v[218:219], v[204:205], v[206:207]
    v_exp_f32 v209, v153
    v_cvt_pk_bf16_f32 v162, v204, v205
    v_exp_f32 v210, v154
    v_pk_add_f32 v[216:217], v[216:217], v[218:219]
    v_exp_f32 v211, v155
    v_cvt_pk_bf16_f32 v163, v206, v207
    v_exp_f32 v212, v156
    v_pk_add_f32 v[220:221], v[208:209], v[210:211]
    v_add_f32 v250, v216, v217
    v_exp_f32 v213, v157
    v_cvt_pk_bf16_f32 v164, v208, v209
    v_exp_f32 v214, v158
    v_cvt_pk_bf16_f32 v165, v210, v211
    v_exp_f32 v215, v159
    v_cmp_lt_f32 vcc, s47, v250
    v_pk_add_f32 v[222:223], v[212:213], v[214:215]
    v_cvt_pk_bf16_f32 v166, v212, v213
    v_pk_add_f32 v[220:221], v[220:221], v[222:223]
    v_cvt_pk_bf16_f32 v167, v214, v215
    v_add_f32 v251, v220, v221
    v_cmp_lt_f32 s[60:61], s47, v251
    s_nop 0
    s_or_b64 s[60:61], s[60:61], vcc
    s_cbranch_scc1 A_rare1
    s_waitcnt lgkmcnt(10)
    v_mfma_f32_16x16x32_bf16 v[0:3], v[168:171], v[160:163], v[0:3]
    ds_read_b64_tr_b16 v[192:193], v228 offset:128
    ds_read_b64_tr_b16 v[194:195], v228 offset:6272
    v_mfma_f32_16x16x32_bf16 v[4:7], v[168:171], v[164:167], v[4:7]
    ds_read_b128 v[96:99], v248 offset:0
    ds_read_b128 v[120:123], v248 offset:1024
    s_waitcnt lgkmcnt(12)
    v_mfma_f32_16x16x32_bf16 v[12:15], v[172:175], v[164:167], v[12:15]
    ds_read_b64_tr_b16 v[196:197], v229 offset:128
    ds_read_b64_tr_b16 v[198:199], v229 offset:6272
    v_mfma_f32_16x16x32_bf16 v[8:11], v[172:175], v[160:163], v[8:11]
    ds_read_b128 v[100:103], v248 offset:6144
    s_waitcnt lgkmcnt(14)
    ds_read_b128 v[124:127], v248 offset:7168
    s_waitcnt lgkmcnt(14)
    v_mfma_f32_16x16x32_bf16 v[16:19], v[176:179], v[160:163], v[16:19]
    ds_read_b64_tr_b16 v[168:169], v226 offset:256
    s_waitcnt lgkmcnt(14)
    ds_read_b64_tr_b16 v[170:171], v226 offset:6400
    v_mfma_f32_16x16x32_bf16 v[20:23], v[176:179], v[164:167], v[20:23]
    s_waitcnt lgkmcnt(14)
    ds_read_b128 v[104:107], v248 offset:12288
    s_waitcnt lgkmcnt(14)
    ds_read_b128 v[128:131], v248 offset:13312
    v_mfma_f32_16x16x32_bf16 v[28:31], v[180:183], v[164:167], v[28:31]
    s_waitcnt lgkmcnt(14)
    ds_read_b64_tr_b16 v[172:173], v227 offset:256
    s_waitcnt lgkmcnt(14)
    ds_read_b64_tr_b16 v[174:175], v227 offset:6400
    v_mfma_f32_16x16x32_bf16 v[24:27], v[180:183], v[160:163], v[24:27]
    s_waitcnt lgkmcnt(14)
    ds_read_b128 v[108:111], v248 offset:18432
    s_waitcnt lgkmcnt(14)
    ds_read_b128 v[132:135], v248 offset:19456
    v_mfma_f32_16x16x32_bf16 v[32:35], v[184:187], v[160:163], v[32:35]
    s_waitcnt lgkmcnt(14)
    ds_read_b64_tr_b16 v[176:177], v228 offset:256
    s_waitcnt lgkmcnt(14)
    ds_read_b64_tr_b16 v[178:179], v228 offset:6400
    v_mfma_f32_16x16x32_bf16 v[36:39], v[184:187], v[164:167], v[36:39]
    s_waitcnt lgkmcnt(14)
    ds_read_b128 v[112:115], v248 offset:24576
    s_waitcnt lgkmcnt(14)
    ds_read_b128 v[136:139], v248 offset:25600
    v_mfma_f32_16x16x32_bf16 v[44:47], v[188:191], v[164:167], v[44:47]
    s_waitcnt lgkmcnt(14)
    ds_read_b64_tr_b16 v[180:181], v229 offset:256
    s_waitcnt lgkmcnt(14)
    ds_read_b64_tr_b16 v[182:183], v229 offset:6400
    v_mfma_f32_16x16x32_bf16 v[40:43], v[188:191], v[160:163], v[40:43]
    s_waitcnt lgkmcnt(14)
    ds_read_b128 v[116:119], v248 offset:30720
    s_waitcnt lgkmcnt(14)
    ds_read_b128 v[140:143], v248 offset:31744
    v_mfma_f32_16x16x32_bf16 v[48:51], v[192:195], v[160:163], v[48:51]
    s_waitcnt lgkmcnt(14)
    ds_read_b128 v[200:203], v224 offset:0
    v_add_f32 v230, v230, v250
    v_mfma_f32_16x16x32_bf16 v[52:55], v[192:195], v[164:167], v[52:55]
    s_waitcnt lgkmcnt(14)
    ds_read_b128 v[204:207], v224 offset:6144
    v_add_f32 v231, v231, v251
    v_mov_b32 v240, v230
    v_mfma_f32_16x16x32_bf16 v[60:63], v[196:199], v[164:167], v[60:63]
    s_waitcnt lgkmcnt(14)
    ds_read_b128 v[208:211], v225 offset:0
    v_mov_b32 v242, v231
    v_mfma_f32_16x16x32_bf16 v[56:59], v[196:199], v[160:163], v[56:59]
    s_waitcnt lgkmcnt(14)
    ds_read_b128 v[212:215], v225 offset:6144
    v_mov_b32 v241, v230
    v_mov_b32 v243, v231
    v_mfma_f32_16x16x32_bf16 v[64:67], v[168:171], v[160:163], v[64:67]
    s_waitcnt lgkmcnt(14)
    ds_read_b128 v[216:219], v224 offset:128
    v_permlane32_swap_b32 v240, v241
    v_mfma_f32_16x16x32_bf16 v[68:71], v[168:171], v[164:167], v[68:71]
    s_waitcnt lgkmcnt(14)
    ds_read_b128 v[220:223], v224 offset:6272
    v_permlane32_swap_b32 v242, v243
    v_add_f32 v240, v240, v241
    v_mfma_f32_16x16x32_bf16 v[76:79], v[172:175], v[164:167], v[76:79]
    s_waitcnt lgkmcnt(14)
    ds_read_b128 v[184:187], v225 offset:128
    v_add_f32 v242, v242, v243
    v_mfma_f32_16x16x32_bf16 v[72:75], v[172:175], v[160:163], v[72:75]
    s_waitcnt lgkmcnt(14)
    ds_read_b128 v[188:191], v225 offset:6272
    v_mov_b32 v241, v240
    v_mov_b32 v243, v242
    s_waitcnt lgkmcnt(14)
    v_mfma_f32_16x16x32_bf16 v[80:83], v[176:179], v[160:163], v[80:83]
    ds_read_b128 v[192:195], v224 offset:256
    v_permlane16_swap_b32 v240, v241
    v_mfma_f32_16x16x32_bf16 v[84:87], v[176:179], v[164:167], v[84:87]
    s_waitcnt lgkmcnt(14)
    ds_read_b128 v[196:199], v224 offset:6400
    v_permlane16_swap_b32 v242, v243
    v_add_f32 v240, v240, v241
    s_waitcnt lgkmcnt(12)
    v_mfma_f32_16x16x32_bf16 v[92:95], v[180:183], v[164:167], v[92:95]
    ds_read_b128 v[168:171], v225 offset:256
    v_add_f32 v242, v242, v243
    v_mfma_f32_16x16x32_bf16 v[88:91], v[180:183], v[160:163], v[88:91]
    ds_read_b128 v[172:175], v225 offset:6400
    v_rcp_f32 v244, v240
    v_rcp_f32 v246, v242
    v_add_u32 v224, s49, v224
    v_add_u32 v225, s49, v225
    v_add_u32 v226, s49, v226
    v_add_u32 v227, s49, v227
    v_add_u32 v228, s49, v228
    v_add_u32 v229, s49, v229
    s_waitcnt lgkmcnt(11)
    v_mfma_f32_16x16x32_bf16 v[144:147], v[200:203], v[96:99], 0
    v_mul_f32 v0, v0, v244
    v_mul_f32 v1, v1, v244
    v_mul_f32 v2, v2, v244
    v_mul_f32 v3, v3, v244
    v_mul_f32 v8, v8, v244
    v_mul_f32 v9, v9, v244
    v_mul_f32 v10, v10, v244
    v_mul_f32 v11, v11, v244
    v_mfma_f32_16x16x32_bf16 v[152:155], v[200:203], v[120:123], 0
    v_cvt_pk_bf16_f32 v0, v0, v1
    v_cvt_pk_bf16_f32 v1, v2, v3
    v_cvt_pk_bf16_f32 v2, v8, v9
    v_cvt_pk_bf16_f32 v3, v10, v11
    ds_write_b128 v248, v[0:3] offset:0
    s_waitcnt lgkmcnt(11)
    v_mfma_f32_16x16x32_bf16 v[156:159], v[204:207], v[120:123], 0
    v_mul_f32 v4, v4, v246
    v_mul_f32 v5, v5, v246
    v_mul_f32 v6, v6, v246
    v_mul_f32 v7, v7, v246
    v_mul_f32 v12, v12, v246
    v_mul_f32 v13, v13, v246
    v_mul_f32 v14, v14, v246
    v_mul_f32 v15, v15, v246
    v_mfma_f32_16x16x32_bf16 v[148:151], v[204:207], v[96:99], 0
    v_cvt_pk_bf16_f32 v4, v4, v5
    v_cvt_pk_bf16_f32 v5, v6, v7
    v_cvt_pk_bf16_f32 v6, v12, v13
    v_cvt_pk_bf16_f32 v7, v14, v15
    ds_write_b128 v248, v[4:7] offset:1024
    s_waitcnt lgkmcnt(11)
    v_mfma_f32_16x16x32_bf16 v[144:147], v[208:211], v[100:103], v[144:147]
    v_mul_f32 v16, v16, v244
    v_mul_f32 v17, v17, v244
    v_mul_f32 v18, v18, v244
    v_mul_f32 v19, v19, v244
    v_mul_f32 v24, v24, v244
    v_mul_f32 v25, v25, v244
    v_mul_f32 v26, v26, v244
    v_mul_f32 v27, v27, v244
    v_mfma_f32_16x16x32_bf16 v[152:155], v[208:211], v[124:127], v[152:155]
    v_cvt_pk_bf16_f32 v16, v16, v17
    v_cvt_pk_bf16_f32 v17, v18, v19
    v_cvt_pk_bf16_f32 v18, v24, v25
    v_cvt_pk_bf16_f32 v19, v26, v27
    ds_write_b128 v248, v[16:19] offset:6144
    s_waitcnt lgkmcnt(11)
    v_mfma_f32_16x16x32_bf16 v[156:159], v[212:215], v[124:127], v[156:159]
    v_mul_f32 v20, v20, v246
    v_mul_f32 v21, v21, v246
    v_mul_f32 v22, v22, v246
    v_mul_f32 v23, v23, v246
    v_mul_f32 v28, v28, v246
    v_mul_f32 v29, v29, v246
    v_mul_f32 v30, v30, v246
    v_mul_f32 v31, v31, v246
    v_mfma_f32_16x16x32_bf16 v[148:151], v[212:215], v[100:103], v[148:151]
    v_cvt_pk_bf16_f32 v20, v20, v21
    v_cvt_pk_bf16_f32 v21, v22, v23
    v_cvt_pk_bf16_f32 v22, v28, v29
    v_cvt_pk_bf16_f32 v23, v30, v31
    ds_write_b128 v248, v[20:23] offset:7168
    s_waitcnt lgkmcnt(11)
    v_mfma_f32_16x16x32_bf16 v[144:147], v[216:219], v[104:107], v[144:147]
    v_mul_f32 v32, v32, v244
    v_mul_f32 v33, v33, v244
    v_mul_f32 v34, v34, v244
    v_mul_f32 v35, v35, v244
    v_mul_f32 v40, v40, v244
    v_mul_f32 v41, v41, v244
    v_mul_f32 v42, v42, v244
    v_mul_f32 v43, v43, v244
    v_mfma_f32_16x16x32_bf16 v[152:155], v[216:219], v[128:131], v[152:155]
    v_cvt_pk_bf16_f32 v32, v32, v33
    v_cvt_pk_bf16_f32 v33, v34, v35
    v_cvt_pk_bf16_f32 v34, v40, v41
    v_cvt_pk_bf16_f32 v35, v42, v43
    ds_write_b128 v248, v[32:35] offset:12288
    s_waitcnt lgkmcnt(11)
    v_mfma_f32_16x16x32_bf16 v[156:159], v[220:223], v[128:131], v[156:159]
    v_mul_f32 v36, v36, v246
    v_mul_f32 v37, v37, v246
    v_mul_f32 v38, v38, v246
    v_mul_f32 v39, v39, v246
    v_mul_f32 v44, v44, v246
    v_mul_f32 v45, v45, v246
    v_mul_f32 v46, v46, v246
    v_mul_f32 v47, v47, v246
    v_mfma_f32_16x16x32_bf16 v[148:151], v[220:223], v[104:107], v[148:151]
    v_cvt_pk_bf16_f32 v36, v36, v37
    v_cvt_pk_bf16_f32 v37, v38, v39
    v_cvt_pk_bf16_f32 v38, v44, v45
    v_cvt_pk_bf16_f32 v39, v46, v47
    ds_write_b128 v248, v[36:39] offset:13312
    s_waitcnt lgkmcnt(11)
    v_mfma_f32_16x16x32_bf16 v[144:147], v[184:187], v[108:111], v[144:147]
    v_mul_f32 v48, v48, v244
    v_mul_f32 v49, v49, v244
    v_mul_f32 v50, v50, v244
    v_mul_f32 v51, v51, v244
    v_mul_f32 v56, v56, v244
    v_mul_f32 v57, v57, v244
    v_mul_f32 v58, v58, v244
    v_mul_f32 v59, v59, v244
    v_mfma_f32_16x16x32_bf16 v[152:155], v[184:187], v[132:135], v[152:155]
    v_cvt_pk_bf16_f32 v48, v48, v49
    v_cvt_pk_bf16_f32 v49, v50, v51
    v_cvt_pk_bf16_f32 v50, v56, v57
    v_cvt_pk_bf16_f32 v51, v58, v59
    ds_write_b128 v248, v[48:51] offset:18432
    s_waitcnt lgkmcnt(11)
    v_mfma_f32_16x16x32_bf16 v[156:159], v[188:191], v[132:135], v[156:159]
    v_mul_f32 v52, v52, v246
    v_mul_f32 v53, v53, v246
    v_mul_f32 v54, v54, v246
    v_mul_f32 v55, v55, v246
    v_mul_f32 v60, v60, v246
    v_mul_f32 v61, v61, v246
    v_mul_f32 v62, v62, v246
    v_mul_f32 v63, v63, v246
    v_mfma_f32_16x16x32_bf16 v[148:151], v[188:191], v[108:111], v[148:151]
    v_cvt_pk_bf16_f32 v52, v52, v53
    v_cvt_pk_bf16_f32 v53, v54, v55
    v_cvt_pk_bf16_f32 v54, v60, v61
    v_cvt_pk_bf16_f32 v55, v62, v63
    ds_write_b128 v248, v[52:55] offset:19456
    s_waitcnt lgkmcnt(11)
    v_mfma_f32_16x16x32_bf16 v[144:147], v[192:195], v[112:115], v[144:147]
    v_mul_f32 v64, v64, v244
    v_mul_f32 v65, v65, v244
    v_mul_f32 v66, v66, v244
    v_mul_f32 v67, v67, v244
    v_mul_f32 v72, v72, v244
    v_mul_f32 v73, v73, v244
    v_mul_f32 v74, v74, v244
    v_mul_f32 v75, v75, v244
    v_mfma_f32_16x16x32_bf16 v[152:155], v[192:195], v[136:139], v[152:155]
    v_cvt_pk_bf16_f32 v64, v64, v65
    v_cvt_pk_bf16_f32 v65, v66, v67
    v_cvt_pk_bf16_f32 v66, v72, v73
    v_cvt_pk_bf16_f32 v67, v74, v75
    ds_write_b128 v248, v[64:67] offset:24576
    s_waitcnt lgkmcnt(11)
    v_mfma_f32_16x16x32_bf16 v[156:159], v[196:199], v[136:139], v[156:159]
    v_mul_f32 v68, v68, v246
    v_mul_f32 v69, v69, v246
    v_mul_f32 v70, v70, v246
    v_mul_f32 v71, v71, v246
    v_mul_f32 v76, v76, v246
    v_mul_f32 v77, v77, v246
    v_mul_f32 v78, v78, v246
    v_mul_f32 v79, v79, v246
    v_mfma_f32_16x16x32_bf16 v[148:151], v[196:199], v[112:115], v[148:151]
    v_cvt_pk_bf16_f32 v68, v68, v69
    v_cvt_pk_bf16_f32 v69, v70, v71
    v_cvt_pk_bf16_f32 v70, v76, v77
    v_cvt_pk_bf16_f32 v71, v78, v79
    ds_write_b128 v248, v[68:71] offset:25600
    s_waitcnt lgkmcnt(11)
    v_mfma_f32_16x16x32_bf16 v[144:147], v[168:171], v[116:119], v[144:147]
    v_mul_f32 v80, v80, v244
    v_mul_f32 v81, v81, v244
    v_mul_f32 v82, v82, v244
    v_mul_f32 v83, v83, v244
    v_mul_f32 v88, v88, v244
    v_mul_f32 v89, v89, v244
    v_mul_f32 v90, v90, v244
    v_mul_f32 v91, v91, v244
    v_mfma_f32_16x16x32_bf16 v[152:155], v[168:171], v[140:143], v[152:155]
    v_cvt_pk_bf16_f32 v80, v80, v81
    v_cvt_pk_bf16_f32 v81, v82, v83
    v_cvt_pk_bf16_f32 v82, v88, v89
    v_cvt_pk_bf16_f32 v83, v90, v91
    ds_write_b128 v248, v[80:83] offset:30720
    s_waitcnt lgkmcnt(11)
    v_mfma_f32_16x16x32_bf16 v[156:159], v[172:175], v[140:143], v[156:159]
    v_mul_f32 v84, v84, v246
    v_mul_f32 v85, v85, v246
    v_mul_f32 v86, v86, v246
    v_mul_f32 v87, v87, v246
    v_mul_f32 v92, v92, v246
    v_mul_f32 v93, v93, v246
    v_mul_f32 v94, v94, v246
    v_mul_f32 v95, v95, v246
    v_mfma_f32_16x16x32_bf16 v[148:151], v[172:175], v[116:119], v[148:151]
    v_cvt_pk_bf16_f32 v84, v84, v85
    v_cvt_pk_bf16_f32 v85, v86, v87
    v_cvt_pk_bf16_f32 v86, v92, v93
    v_cvt_pk_bf16_f32 v87, v94, v95
    ds_write_b128 v248, v[84:87] offset:31744
    s_waitcnt lgkmcnt(0)
    s_branch A_unit
A_done:
    s_setprio 2
    s_barrier
    ds_read_b64_tr_b16 v[168:169], v226 offset:0
    ds_read_b64_tr_b16 v[170:171], v226 offset:6144
    ds_read_b64_tr_b16 v[172:173], v227 offset:0
    ds_read_b64_tr_b16 v[174:175], v227 offset:6144
    ds_read_b64_tr_b16 v[176:177], v228 offset:0
    ds_read_b64_tr_b16 v[178:179], v228 offset:6144
    ds_read_b64_tr_b16 v[180:181], v229 offset:0
    ds_read_b64_tr_b16 v[182:183], v229 offset:6144
    ds_read_b64_tr_b16 v[184:185], v226 offset:128
    ds_read_b64_tr_b16 v[186:187], v226 offset:6272
    ds_read_b64_tr_b16 v[188:189], v227 offset:128
    ds_read_b64_tr_b16 v[190:191], v227 offset:6272
    s_add_u32 s48, s48, 1
    s_cmp_eq_u32 s48, 3
    s_cselect_b32 s48, 0, s48
    s_cselect_b32 s49, 4294918144, s45
A_rare2_ret:
    v_exp_f32 v200, v144
    v_exp_f32 v201, v145
    v_exp_f32 v202, v146
    v_exp_f32 v203, v147
    v_exp_f32 v204, v148
    v_pk_add_f32 v[216:217], v[200:201], v[202:203]
    v_exp_f32 v205, v149
    v_cvt_pk_bf16_f32 v160, v200, v201
    v_exp_f32 v206, v150
    v_cvt_pk_bf16_f32 v161, v202, v203
    v_exp_f32 v207, v151
    v_exp_f32 v208, v152
    v_pk_add_f32 v[218:219], v[204:205], v[206:207]
    v_exp_f32 v209, v153
    v_cvt_pk_bf16_f32 v162, v204, v205
    v_exp_f32 v210, v154
    v_pk_add_f32 v[216:217], v[216:217], v[218:219]
    v_exp_f32 v211, v155
    v_cvt_pk_bf16_f32 v163, v206, v207
    v_exp_f32 v212, v156
    v_pk_add_f32 v[220:221], v[208:209], v[210:211]
    v_add_f32 v250, v216, v217
    v_exp_f32 v213, v157
    v_cvt_pk_bf16_f32 v164, v208, v209
    v_exp_f32 v214, v158
    v_cvt_pk_bf16_f32 v165, v210, v211
    v_exp_f32 v215, v159
    v_cmp_lt_f32 vcc, s47, v250
    v_pk_add_f32 v[222:223], v[212:213], v[214:215]
    v_cvt_pk_bf16_f32 v166, v212, v213
    v_pk_add_f32 v[220:221], v[220:221], v[222:223]
    v_cvt_pk_bf16_f32 v167, v214, v215
    v_add_f32 v251, v220, v221
    v_cmp_lt_f32 s[60:61], s47, v251
    s_nop 0
    s_or_b64 s[60:61], s[60:61], vcc
    s_cbranch_scc1 A_rare2
    s_waitcnt lgkmcnt(10)
    v_mfma_f32_16x16x32_bf16 v[0:3], v[168:171], v[160:163], v[0:3]
    ds_read_b64_tr_b16 v[192:193], v228 offset:128
    v_add_f32 v230, v230, v250
    v_add_f32 v231, v231, v251
    v_mov_b32 v240, v230
    v_mov_b32 v242, v231
    v_mfma_f32_16x16x32_bf16 v[4:7], v[168:171], v[164:167], v[4:7]
    ds_read_b64_tr_b16 v[194:195], v228 offset:6272
    v_mov_b32 v241, v230
    v_mov_b32 v243, v231
    s_nop 0
    v_permlane32_swap_b32 v240, v241
    s_nop 0
    v_permlane32_swap_b32 v242, v243
    s_waitcnt lgkmcnt(10)
    v_mfma_f32_16x16x32_bf16 v[12:15], v[172:175], v[164:167], v[12:15]
    ds_read_b64_tr_b16 v[196:197], v229 offset:128
    v_add_f32 v240, v240, v241
    v_add_f32 v242, v242, v243
    v_mov_b32 v241, v240
    v_mov_b32 v243, v242
    v_mfma_f32_16x16x32_bf16 v[8:11], v[172:175], v[160:163], v[8:11]
    ds_read_b64_tr_b16 v[198:199], v229 offset:6272
    v_permlane16_swap_b32 v240, v241
    v_permlane16_swap_b32 v242, v243
    v_add_f32 v240, v240, v241
    v_add_f32 v242, v242, v243
    s_waitcnt lgkmcnt(10)
    v_mfma_f32_16x16x32_bf16 v[16:19], v[176:179], v[160:163], v[16:19]
    ds_read_b64_tr_b16 v[168:169], v226 offset:256
    v_rcp_f32 v244, v240
    v_mfma_f32_16x16x32_bf16 v[20:23], v[176:179], v[164:167], v[20:23]
    ds_read_b64_tr_b16 v[170:171], v226 offset:6400
    v_rcp_f32 v246, v242
    s_waitcnt lgkmcnt(10)
    v_mfma_f32_16x16x32_bf16 v[28:31], v[180:183], v[164:167], v[28:31]
    ds_read_b64_tr_b16 v[172:173], v227 offset:256
    v_mfma_f32_16x16x32_bf16 v[24:27], v[180:183], v[160:163], v[24:27]
    ds_read_b64_tr_b16 v[174:175], v227 offset:6400
    v_mul_f32 v0, v0, v244
    v_mul_f32 v1, v1, v244
    v_mul_f32 v2, v2, v244
    v_mul_f32 v3, v3, v244
    v_mul_f32 v8, v8, v244
    v_mul_f32 v9, v9, v244
    v_mul_f32 v10, v10, v244
    v_mul_f32 v11, v11, v244
    v_cvt_pk_bf16_f32 v0, v0, v1
    v_cvt_pk_bf16_f32 v1, v2, v3
    v_cvt_pk_bf16_f32 v2, v8, v9
    v_cvt_pk_bf16_f32 v3, v10, v11
    ds_write_b128 v249, v[0:3] offset:0
    s_waitcnt lgkmcnt(11)
    v_mfma_f32_16x16x32_bf16 v[32:35], v[184:187], v[160:163], v[32:35]
    ds_read_b64_tr_b16 v[176:177], v228 offset:256
    v_mfma_f32_16x16x32_bf16 v[36:39], v[184:187], v[164:167], v[36:39]
    ds_read_b64_tr_b16 v[178:179], v228 offset:6400
    v_mul_f32 v4, v4, v246
    v_mul_f32 v5, v5, v246
    v_mul_f32 v6, v6, v246
    v_mul_f32 v7, v7, v246
    v_mul_f32 v12, v12, v246
    v_mul_f32 v13, v13, v246
    v_mul_f32 v14, v14, v246
    v_mul_f32 v15, v15, v246
    v_cvt_pk_bf16_f32 v4, v4, v5
    v_cvt_pk_bf16_f32 v5, v6, v7
    v_cvt_pk_bf16_f32 v6, v12, v13
    v_cvt_pk_bf16_f32 v7, v14, v15
    ds_write_b128 v249, v[4:7] offset:1024
    s_barrier
    s_waitcnt lgkmcnt(12)
    v_mfma_f32_16x16x32_bf16 v[44:47], v[188:191], v[164:167], v[44:47]
    ds_read_b64_tr_b16 v[180:181], v229 offset:256
    v_mfma_f32_16x16x32_bf16 v[40:43], v[188:191], v[160:163], v[40:43]
    ds_read_b64_tr_b16 v[182:183], v229 offset:6400
    v_mul_f32 v16, v16, v244
    v_mul_f32 v17, v17, v244
    v_mul_f32 v18, v18, v244
    v_mul_f32 v19, v19, v244
    v_mul_f32 v24, v24, v244
    v_mul_f32 v25, v25, v244
    v_mul_f32 v26, v26, v244
    v_mul_f32 v27, v27, v244
    v_cvt_pk_bf16_f32 v16, v16, v17
    v_cvt_pk_bf16_f32 v17, v18, v19
    v_cvt_pk_bf16_f32 v18, v24, v25
    v_cvt_pk_bf16_f32 v19, v26, v27
    ds_write_b128 v249, v[16:19] offset:6144
    s_waitcnt lgkmcnt(13)
    v_mfma_f32_16x16x32_bf16 v[48:51], v[192:195], v[160:163], v[48:51]
    v_mfma_f32_16x16x32_bf16 v[52:55], v[192:195], v[164:167], v[52:55]
    v_mul_f32 v20, v20, v246
    v_mul_f32 v21, v21, v246
    v_mul_f32 v22, v22, v246
    v_mul_f32 v23, v23, v246
    v_mul_f32 v28, v28, v246
    v_mul_f32 v29, v29, v246
    v_mul_f32 v30, v30, v246
    v_mul_f32 v31, v31, v246
    v_cvt_pk_bf16_f32 v20, v20, v21
    v_cvt_pk_bf16_f32 v21, v22, v23
    v_cvt_pk_bf16_f32 v22, v28, v29
    v_cvt_pk_bf16_f32 v23, v30, v31
    ds_write_b128 v249, v[20:23] offset:7168
    s_waitcnt lgkmcnt(12)
    v_mfma_f32_16x16x32_bf16 v[60:63], v[196:199], v[164:167], v[60:63]
    v_mfma_f32_16x16x32_bf16 v[56:59], v[196:199], v[160:163], v[56:59]
    v_mul_f32 v32, v32, v244
    v_mul_f32 v33, v33, v244
    v_mul_f32 v34, v34, v244
    v_mul_f32 v35, v35, v244
    v_mul_f32 v40, v40, v244
    v_mul_f32 v41, v41, v244
    v_mul_f32 v42, v42, v244
    v_mul_f32 v43, v43, v244
    v_cvt_pk_bf16_f32 v32, v32, v33
    v_cvt_pk_bf16_f32 v33, v34, v35
    v_cvt_pk_bf16_f32 v34, v40, v41
    v_cvt_pk_bf16_f32 v35, v42, v43
    ds_write_b128 v249, v[32:35] offset:12288
    s_waitcnt lgkmcnt(11)
    v_mfma_f32_16x16x32_bf16 v[64:67], v[168:171], v[160:163], v[64:67]
    v_mfma_f32_16x16x32_bf16 v[68:71], v[168:171], v[164:167], v[68:71]
    v_mul_f32 v36, v36, v246
    v_mul_f32 v37, v37, v246
    v_mul_f32 v38, v38, v246
    v_mul_f32 v39, v39, v246
    v_mul_f32 v44, v44, v246
    v_mul_f32 v45, v45, v246
    v_mul_f32 v46, v46, v246
    v_mul_f32 v47, v47, v246
    v_cvt_pk_bf16_f32 v36, v36, v37
    v_cvt_pk_bf16_f32 v37, v38, v39
    v_cvt_pk_bf16_f32 v38, v44, v45
    v_cvt_pk_bf16_f32 v39, v46, v47
    ds_write_b128 v249, v[36:39] offset:13312
    s_waitcnt lgkmcnt(10)
    v_mfma_f32_16x16x32_bf16 v[76:79], v[172:175], v[164:167], v[76:79]
    v_mfma_f32_16x16x32_bf16 v[72:75], v[172:175], v[160:163], v[72:75]
    v_mul_f32 v48, v48, v244
    v_mul_f32 v49, v49, v244
    v_mul_f32 v50, v50, v244
    v_mul_f32 v51, v51, v244
    v_mul_f32 v56, v56, v244
    v_mul_f32 v57, v57, v244
    v_mul_f32 v58, v58, v244
    v_mul_f32 v59, v59, v244
    v_cvt_pk_bf16_f32 v48, v48, v49
    v_cvt_pk_bf16_f32 v49, v50, v51
    v_cvt_pk_bf16_f32 v50, v56, v57
    v_cvt_pk_bf16_f32 v51, v58, v59
    ds_write_b128 v249, v[48:51] offset:18432
    s_waitcnt lgkmcnt(8)
    v_mfma_f32_16x16x32_bf16 v[80:83], v[176:179], v[160:163], v[80:83]
    v_mfma_f32_16x16x32_bf16 v[84:87], v[176:179], v[164:167], v[84:87]
    v_mul_f32 v52, v52, v246
    v_mul_f32 v53, v53, v246
    v_mul_f32 v54, v54, v246
    v_mul_f32 v55, v55, v246
    v_mul_f32 v60, v60, v246
    v_mul_f32 v61, v61, v246
    v_mul_f32 v62, v62, v246
    v_mul_f32 v63, v63, v246
    v_cvt_pk_bf16_f32 v52, v52, v53
    v_cvt_pk_bf16_f32 v53, v54, v55
    v_cvt_pk_bf16_f32 v54, v60, v61
    v_cvt_pk_bf16_f32 v55, v62, v63
    ds_write_b128 v249, v[52:55] offset:19456
    s_waitcnt lgkmcnt(6)
    v_mfma_f32_16x16x32_bf16 v[92:95], v[180:183], v[164:167], v[92:95]
    v_mfma_f32_16x16x32_bf16 v[88:91], v[180:183], v[160:163], v[88:91]
    v_mul_f32 v64, v64, v244
    v_mul_f32 v65, v65, v244
    v_mul_f32 v66, v66, v244
    v_mul_f32 v67, v67, v244
    v_mul_f32 v72, v72, v244
    v_mul_f32 v73, v73, v244
    v_mul_f32 v74, v74, v244
    v_mul_f32 v75, v75, v244
    v_cvt_pk_bf16_f32 v64, v64, v65
    v_cvt_pk_bf16_f32 v65, v66, v67
    v_cvt_pk_bf16_f32 v66, v72, v73
    v_cvt_pk_bf16_f32 v67, v74, v75
    ds_write_b128 v249, v[64:67] offset:24576
    v_mul_f32 v68, v68, v246
    v_mul_f32 v69, v69, v246
    v_mul_f32 v70, v70, v246
    v_mul_f32 v71, v71, v246
    v_mul_f32 v76, v76, v246
    v_mul_f32 v77, v77, v246
    v_mul_f32 v78, v78, v246
    v_mul_f32 v79, v79, v246
    v_cvt_pk_bf16_f32 v68, v68, v69
    v_cvt_pk_bf16_f32 v69, v70, v71
    v_cvt_pk_bf16_f32 v70, v76, v77
    v_cvt_pk_bf16_f32 v71, v78, v79
    ds_write_b128 v249, v[68:71] offset:25600
    v_mul_f32 v80, v80, v244
    v_mul_f32 v81, v81, v244
    v_mul_f32 v82, v82, v244
    v_mul_f32 v83, v83, v244
    v_mul_f32 v88, v88, v244
    v_mul_f32 v89, v89, v244
    v_mul_f32 v90, v90, v244
    v_mul_f32 v91, v91, v244
    v_cvt_pk_bf16_f32 v80, v80, v81
    v_cvt_pk_bf16_f32 v81, v82, v83
    v_cvt_pk_bf16_f32 v82, v88, v89
    v_cvt_pk_bf16_f32 v83, v90, v91
    ds_write_b128 v249, v[80:83] offset:30720
    v_mul_f32 v84, v84, v246
    v_mul_f32 v85, v85, v246
    v_mul_f32 v86, v86, v246
    v_mul_f32 v87, v87, v246
    v_mul_f32 v92, v92, v246
    v_mul_f32 v93, v93, v246
    v_mul_f32 v94, v94, v246
    v_mul_f32 v95, v95, v246
    v_cvt_pk_bf16_f32 v84, v84, v85
    v_cvt_pk_bf16_f32 v85, v86, v87
    v_cvt_pk_bf16_f32 v86, v92, v93
    v_cvt_pk_bf16_f32 v87, v94, v95
    ds_write_b128 v249, v[84:87] offset:31744
    s_waitcnt lgkmcnt(0)
    s_endpgm
A_touch:
    buffer_load_dword v100, v108, s[20:23], s60 offen
    buffer_load_dword v100, v107, s[12:15], s61 offen
    buffer_load_dword v100, v108, s[20:23], s60 offen offset:128
    s_cmp_eq_u32 s3, 2
    s_cbranch_scc1 A_touch2
    buffer_load_dword v100, v108, s[20:23], s60 offen offset:256
    buffer_load_dword v100, v108, s[20:23], s60 offen offset:384
    s_branch A_tr1
A_touch2:
    buffer_load_dword v100, v109, s[12:15], s61 offen offset:768
    s_branch A_tr1
A_rare0:
    v_max3_f32 v250, v144, v145, v146
    v_max3_f32 v251, v152, v153, v154
    v_max3_f32 v250, v250, v147, v148
    v_max3_f32 v251, v251, v155, v156
    v_max3_f32 v250, v250, v149, v150
    v_max3_f32 v251, v251, v157, v158
    v_max_f32 v250, v250, v151
    v_max_f32 v251, v251, v159
    v_mov_b32 v240, v250
    v_mov_b32 v242, v251
    v_mov_b32 v241, v250
    v_mov_b32 v243, v251
    s_nop 0
    v_permlane32_swap_b32 v240, v241
    s_nop 0
    v_permlane32_swap_b32 v242, v243
    v_max_f32 v240, v240, v241
    v_max_f32 v242, v242, v243
    v_mov_b32 v241, v240
    v_mov_b32 v243, v242
    s_nop 0
    v_permlane16_swap_b32 v240, v241
    s_nop 0
    v_permlane16_swap_b32 v242, v243
    v_max_f32 v240, v240, v241
    v_max_f32 v242, v242, v243
    v_max_f32 v240, 0, v240
    v_max_f32 v242, 0, v242
    v_exp_f32 v241, -v240
    v_exp_f32 v243, -v242
    v_mul_f32 v230, v230, v241
    v_mul_f32 v231, v231, v243
    v_mul_f32 v0, v0, v241
    v_mul_f32 v1, v1, v241
    v_mul_f32 v2, v2, v241
    v_mul_f32 v3, v3, v241
    v_mul_f32 v4, v4, v243
    v_mul_f32 v5, v5, v243
    v_mul_f32 v6, v6, v243
    v_mul_f32 v7, v7, v243
    v_mul_f32 v8, v8, v241
    v_mul_f32 v9, v9, v241
    v_mul_f32 v10, v10, v241
    v_mul_f32 v11, v11, v241
    v_mul_f32 v12, v12, v243
    v_mul_f32 v13, v13, v243
    v_mul_f32 v14, v14, v243
    v_mul_f32 v15, v15, v243
    v_mul_f32 v16, v16, v241
    v_mul_f32 v17, v17, v241
    v_mul_f32 v18, v18, v241
    v_mul_f32 v19, v19, v241
    v_mul_f32 v20, v20, v243
    v_mul_f32 v21, v21, v243
    v_mul_f32 v22, v22, v243
    v_mul_f32 v23, v23, v243
    v_mul_f32 v24, v24, v241
    v_mul_f32 v25, v25, v241
    v_mul_f32 v26, v26, v241
    v_mul_f32 v27, v27, v241
    v_mul_f32 v28, v28, v243
    v_mul_f32 v29, v29, v243
    v_mul_f32 v30, v30, v243
    v_mul_f32 v31, v31, v243
    v_mul_f32 v32, v32, v241
    v_mul_f32 v33, v33, v241
    v_mul_f32 v34, v34, v241
    v_mul_f32 v35, v35, v241
    v_mul_f32 v36, v36, v243
    v_mul_f32 v37, v37, v243
    v_mul_f32 v38, v38, v243
    v_mul_f32 v39, v39, v243
    v_mul_f32 v40, v40, v241
    v_mul_f32 v41, v41, v241
    v_mul_f32 v42, v42, v241
    v_mul_f32 v43, v43, v241
    v_mul_f32 v44, v44, v243
    v_mul_f32 v45, v45, v243
    v_mul_f32 v46, v46, v243
    v_mul_f32 v47, v47, v243
    v_mul_f32 v48, v48, v241
    v_mul_f32 v49, v49, v241
    v_mul_f32 v50, v50, v241
    v_mul_f32 v51, v51, v241
    v_mul_f32 v52, v52, v243
    v_mul_f32 v53, v53, v243
    v_mul_f32 v54, v54, v243
    v_mul_f32 v55, v55, v243
    v_mul_f32 v56, v56, v241
    v_mul_f32 v57, v57, v241
    v_mul_f32 v58, v58, v241
    v_mul_f32 v59, v59, v241
    v_mul_f32 v60, v60, v243
    v_mul_f32 v61, v61, v243
    v_mul_f32 v62, v62, v243
    v_mul_f32 v63, v63, v243
    v_mul_f32 v64, v64, v241
    v_mul_f32 v65, v65, v241
    v_mul_f32 v66, v66, v241
    v_mul_f32 v67, v67, v241
    v_mul_f32 v68, v68, v243
    v_mul_f32 v69, v69, v243
    v_mul_f32 v70, v70, v243
    v_mul_f32 v71, v71, v243
    v_mul_f32 v72, v72, v241
    v_mul_f32 v73, v73, v241
    v_mul_f32 v74, v74, v241
    v_mul_f32 v75, v75, v241
    v_mul_f32 v76, v76, v243
    v_mul_f32 v77, v77, v243
    v_mul_f32 v78, v78, v243
    v_mul_f32 v79, v79, v243
    v_mul_f32 v80, v80, v241
    v_mul_f32 v81, v81, v241
    v_mul_f32 v82, v82, v241
    v_mul_f32 v83, v83, v241
    v_mul_f32 v84, v84, v243
    v_mul_f32 v85, v85, v243
    v_mul_f32 v86, v86, v243
    v_mul_f32 v87, v87, v243
    v_mul_f32 v88, v88, v241
    v_mul_f32 v89, v89, v241
    v_mul_f32 v90, v90, v241
    v_mul_f32 v91, v91, v241
    v_mul_f32 v92, v92, v243
    v_mul_f32 v93, v93, v243
    v_mul_f32 v94, v94, v243
    v_mul_f32 v95, v95, v243
    v_sub_f32 v144, v144, v240
    v_sub_f32 v145, v145, v240
    v_sub_f32 v146, v146, v240
    v_sub_f32 v147, v147, v240
    v_sub_f32 v148, v148, v240
    v_sub_f32 v149, v149, v240
    v_sub_f32 v150, v150, v240
    v_sub_f32 v151, v151, v240
    v_sub_f32 v232, v232, v240
    v_sub_f32 v233, v233, v240
    v_sub_f32 v234, v234, v240
    v_sub_f32 v235, v235, v240
    v_sub_f32 v152, v152, v242
    v_sub_f32 v153, v153, v242
    v_sub_f32 v154, v154, v242
    v_sub_f32 v155, v155, v242
    v_sub_f32 v156, v156, v242
    v_sub_f32 v157, v157, v242
    v_sub_f32 v158, v158, v242
    v_sub_f32 v159, v159, v242
    v_sub_f32 v236, v236, v242
    v_sub_f32 v237, v237, v242
    v_sub_f32 v238, v238, v242
    v_sub_f32 v239, v239, v242
    s_branch A_rare0_ret
A_rare1:
    v_max3_f32 v250, v144, v145, v146
    v_max3_f32 v251, v152, v153, v154
    v_max3_f32 v250, v250, v147, v148
    v_max3_f32 v251, v251, v155, v156
    v_max3_f32 v250, v250, v149, v150
    v_max3_f32 v251, v251, v157, v158
    v_max_f32 v250, v250, v151
    v_max_f32 v251, v251, v159
    v_mov_b32 v240, v250
    v_mov_b32 v242, v251
    v_mov_b32 v241, v250
    v_mov_b32 v243, v251
    s_nop 0
    v_permlane32_swap_b32 v240, v241
    s_nop 0
    v_permlane32_swap_b32 v242, v243
    v_max_f32 v240, v240, v241
    v_max_f32 v242, v242, v243
    v_mov_b32 v241, v240
    v_mov_b32 v243, v242
    s_nop 0
    v_permlane16_swap_b32 v240, v241
    s_nop 0
    v_permlane16_swap_b32 v242, v243
    v_max_f32 v240, v240, v241
    v_max_f32 v242, v242, v243
    v_max_f32 v240, 0, v240
    v_max_f32 v242, 0, v242
    v_exp_f32 v241, -v240
    v_exp_f32 v243, -v242
    v_mul_f32 v230, v230, v241
    v_mul_f32 v231, v231, v243
    v_mul_f32 v0, v0, v241
    v_mul_f32 v1, v1, v241
    v_mul_f32 v2, v2, v241
    v_mul_f32 v3, v3, v241
    v_mul_f32 v4, v4, v243
    v_mul_f32 v5, v5, v243
    v_mul_f32 v6, v6, v243
    v_mul_f32 v7, v7, v243
    v_mul_f32 v8, v8, v241
    v_mul_f32 v9, v9, v241
    v_mul_f32 v10, v10, v241
    v_mul_f32 v11, v11, v241
    v_mul_f32 v12, v12, v243
    v_mul_f32 v13, v13, v243
    v_mul_f32 v14, v14, v243
    v_mul_f32 v15, v15, v243
    v_mul_f32 v16, v16, v241
    v_mul_f32 v17, v17, v241
    v_mul_f32 v18, v18, v241
    v_mul_f32 v19, v19, v241
    v_mul_f32 v20, v20, v243
    v_mul_f32 v21, v21, v243
    v_mul_f32 v22, v22, v243
    v_mul_f32 v23, v23, v243
    v_mul_f32 v24, v24, v241
    v_mul_f32 v25, v25, v241
    v_mul_f32 v26, v26, v241
    v_mul_f32 v27, v27, v241
    v_mul_f32 v28, v28, v243
    v_mul_f32 v29, v29, v243
    v_mul_f32 v30, v30, v243
    v_mul_f32 v31, v31, v243
    v_mul_f32 v32, v32, v241
    v_mul_f32 v33, v33, v241
    v_mul_f32 v34, v34, v241
    v_mul_f32 v35, v35, v241
    v_mul_f32 v36, v36, v243
    v_mul_f32 v37, v37, v243
    v_mul_f32 v38, v38, v243
    v_mul_f32 v39, v39, v243
    v_mul_f32 v40, v40, v241
    v_mul_f32 v41, v41, v241
    v_mul_f32 v42, v42, v241
    v_mul_f32 v43, v43, v241
    v_mul_f32 v44, v44, v243
    v_mul_f32 v45, v45, v243
    v_mul_f32 v46, v46, v243
    v_mul_f32 v47, v47, v243
    v_mul_f32 v48, v48, v241
    v_mul_f32 v49, v49, v241
    v_mul_f32 v50, v50, v241
    v_mul_f32 v51, v51, v241
    v_mul_f32 v52, v52, v243
    v_mul_f32 v53, v53, v243
    v_mul_f32 v54, v54, v243
    v_mul_f32 v55, v55, v243
    v_mul_f32 v56, v56, v241
    v_mul_f32 v57, v57, v241
    v_mul_f32 v58, v58, v241
    v_mul_f32 v59, v59, v241
    v_mul_f32 v60, v60, v243
    v_mul_f32 v61, v61, v243
    v_mul_f32 v62, v62, v243
    v_mul_f32 v63, v63, v243
    v_mul_f32 v64, v64, v241
    v_mul_f32 v65, v65, v241
    v_mul_f32 v66, v66, v241
    v_mul_f32 v67, v67, v241
    v_mul_f32 v68, v68, v243
    v_mul_f32 v69, v69, v243
    v_mul_f32 v70, v70, v243
    v_mul_f32 v71, v71, v243
    v_mul_f32 v72, v72, v241
    v_mul_f32 v73, v73, v241
    v_mul_f32 v74, v74, v241
    v_mul_f32 v75, v75, v241
    v_mul_f32 v76, v76, v243
    v_mul_f32 v77, v77, v243
    v_mul_f32 v78, v78, v243
    v_mul_f32 v79, v79, v243
    v_mul_f32 v80, v80, v241
    v_mul_f32 v81, v81, v241
    v_mul_f32 v82, v82, v241
    v_mul_f32 v83, v83, v241
    v_mul_f32 v84, v84, v243
    v_mul_f32 v85, v85, v243
    v_mul_f32 v86, v86, v243
    v_mul_f32 v87, v87, v243
    v_mul_f32 v88, v88, v241
    v_mul_f32 v89, v89, v241
    v_mul_f32 v90, v90, v241
    v_mul_f32 v91, v91, v241
    v_mul_f32 v92, v92, v243
    v_mul_f32 v93, v93, v243
    v_mul_f32 v94, v94, v243
    v_mul_f32 v95, v95, v243
    v_sub_f32 v144, v144, v240
    v_sub_f32 v145, v145, v240
    v_sub_f32 v146, v146, v240
    v_sub_f32 v147, v147, v240
    v_sub_f32 v148, v148, v240
    v_sub_f32 v149, v149, v240
    v_sub_f32 v150, v150, v240
    v_sub_f32 v151, v151, v240
    v_sub_f32 v232, v232, v240
    v_sub_f32 v233, v233, v240
    v_sub_f32 v234, v234, v240
    v_sub_f32 v235, v235, v240
    v_sub_f32 v152, v152, v242
    v_sub_f32 v153, v153, v242
    v_sub_f32 v154, v154, v242
    v_sub_f32 v155, v155, v242
    v_sub_f32 v156, v156, v242
    v_sub_f32 v157, v157, v242
    v_sub_f32 v158, v158, v242
    v_sub_f32 v159, v159, v242
    v_sub_f32 v236, v236, v242
    v_sub_f32 v237, v237, v242
    v_sub_f32 v238, v238, v242
    v_sub_f32 v239, v239, v242
    s_branch A_rare1_ret
A_rare2:
    v_max3_f32 v250, v144, v145, v146
    v_max3_f32 v251, v152, v153, v154
    v_max3_f32 v250, v250, v147, v148
    v_max3_f32 v251, v251, v155, v156
    v_max3_f32 v250, v250, v149, v150
    v_max3_f32 v251, v251, v157, v158
    v_max_f32 v250, v250, v151
    v_max_f32 v251, v251, v159
    v_mov_b32 v240, v250
    v_mov_b32 v242, v251
    v_mov_b32 v241, v250
    v_mov_b32 v243, v251
    s_nop 0
    v_permlane32_swap_b32 v240, v241
    s_nop 0
    v_permlane32_swap_b32 v242, v243
    v_max_f32 v240, v240, v241
    v_max_f32 v242, v242, v243
    v_mov_b32 v241, v240
    v_mov_b32 v243, v242
    s_nop 0
    v_permlane16_swap_b32 v240, v241
    s_nop 0
    v_permlane16_swap_b32 v242, v243
    v_max_f32 v240, v240, v241
    v_max_f32 v242, v242, v243
    v_max_f32 v240, 0, v240
    v_max_f32 v242, 0, v242
    v_exp_f32 v241, -v240
    v_exp_f32 v243, -v242
    v_mul_f32 v230, v230, v241
    v_mul_f32 v231, v231, v243
    v_mul_f32 v0, v0, v241
    v_mul_f32 v1, v1, v241
    v_mul_f32 v2, v2, v241
    v_mul_f32 v3, v3, v241
    v_mul_f32 v4, v4, v243
    v_mul_f32 v5, v5, v243
    v_mul_f32 v6, v6, v243
    v_mul_f32 v7, v7, v243
    v_mul_f32 v8, v8, v241
    v_mul_f32 v9, v9, v241
    v_mul_f32 v10, v10, v241
    v_mul_f32 v11, v11, v241
    v_mul_f32 v12, v12, v243
    v_mul_f32 v13, v13, v243
    v_mul_f32 v14, v14, v243
    v_mul_f32 v15, v15, v243
    v_mul_f32 v16, v16, v241
    v_mul_f32 v17, v17, v241
    v_mul_f32 v18, v18, v241
    v_mul_f32 v19, v19, v241
    v_mul_f32 v20, v20, v243
    v_mul_f32 v21, v21, v243
    v_mul_f32 v22, v22, v243
    v_mul_f32 v23, v23, v243
    v_mul_f32 v24, v24, v241
    v_mul_f32 v25, v25, v241
    v_mul_f32 v26, v26, v241
    v_mul_f32 v27, v27, v241
    v_mul_f32 v28, v28, v243
    v_mul_f32 v29, v29, v243
    v_mul_f32 v30, v30, v243
    v_mul_f32 v31, v31, v243
    v_mul_f32 v32, v32, v241
    v_mul_f32 v33, v33, v241
    v_mul_f32 v34, v34, v241
    v_mul_f32 v35, v35, v241
    v_mul_f32 v36, v36, v243
    v_mul_f32 v37, v37, v243
    v_mul_f32 v38, v38, v243
    v_mul_f32 v39, v39, v243
    v_mul_f32 v40, v40, v241
    v_mul_f32 v41, v41, v241
    v_mul_f32 v42, v42, v241
    v_mul_f32 v43, v43, v241
    v_mul_f32 v44, v44, v243
    v_mul_f32 v45, v45, v243
    v_mul_f32 v46, v46, v243
    v_mul_f32 v47, v47, v243
    v_mul_f32 v48, v48, v241
    v_mul_f32 v49, v49, v241
    v_mul_f32 v50, v50, v241
    v_mul_f32 v51, v51, v241
    v_mul_f32 v52, v52, v243
    v_mul_f32 v53, v53, v243
    v_mul_f32 v54, v54, v243
    v_mul_f32 v55, v55, v243
    v_mul_f32 v56, v56, v241
    v_mul_f32 v57, v57, v241
    v_mul_f32 v58, v58, v241
    v_mul_f32 v59, v59, v241
    v_mul_f32 v60, v60, v243
    v_mul_f32 v61, v61, v243
    v_mul_f32 v62, v62, v243
    v_mul_f32 v63, v63, v243
    v_mul_f32 v64, v64, v241
    v_mul_f32 v65, v65, v241
    v_mul_f32 v66, v66, v241
    v_mul_f32 v67, v67, v241
    v_mul_f32 v68, v68, v243
    v_mul_f32 v69, v69, v243
    v_mul_f32 v70, v70, v243
    v_mul_f32 v71, v71, v243
    v_mul_f32 v72, v72, v241
    v_mul_f32 v73, v73, v241
    v_mul_f32 v74, v74, v241
    v_mul_f32 v75, v75, v241
    v_mul_f32 v76, v76, v243
    v_mul_f32 v77, v77, v243
    v_mul_f32 v78, v78, v243
    v_mul_f32 v79, v79, v243
    v_mul_f32 v80, v80, v241
    v_mul_f32 v81, v81, v241
    v_mul_f32 v82, v82, v241
    v_mul_f32 v83, v83, v241
    v_mul_f32 v84, v84, v243
    v_mul_f32 v85, v85, v243
    v_mul_f32 v86, v86, v243
    v_mul_f32 v87, v87, v243
    v_mul_f32 v88, v88, v241
    v_mul_f32 v89, v89, v241
    v_mul_f32 v90, v90, v241
    v_mul_f32 v91, v91, v241
    v_mul_f32 v92, v92, v243
    v_mul_f32 v93, v93, v243
    v_mul_f32 v94, v94, v243
    v_mul_f32 v95, v95, v243
    v_sub_f32 v144, v144, v240
    v_sub_f32 v145, v145, v240
    v_sub_f32 v146, v146, v240
    v_sub_f32 v147, v147, v240
    v_sub_f32 v148, v148, v240
    v_sub_f32 v149, v149, v240
    v_sub_f32 v150, v150, v240
    v_sub_f32 v151, v151, v240
    v_sub_f32 v232, v232, v240
    v_sub_f32 v233, v233, v240
    v_sub_f32 v234, v234, v240
    v_sub_f32 v235, v235, v240
    v_sub_f32 v152, v152, v242
    v_sub_f32 v153, v153, v242
    v_sub_f32 v154, v154, v242
    v_sub_f32 v155, v155, v242
    v_sub_f32 v156, v156, v242
    v_sub_f32 v157, v157, v242
    v_sub_f32 v158, v158, v242
    v_sub_f32 v159, v159, v242
    v_sub_f32 v236, v236, v242
    v_sub_f32 v237, v237, v242
    v_sub_f32 v238, v238, v242
    v_sub_f32 v239, v239, v242
    s_branch A_rare2_ret
L_loader:
    s_setprio 3
    s_getpc_b64 s[64:65]
TB_1:
    s_add_u32 s64, s64, L_table-TB_1
    s_addc_u32 s65, s65, 0
    v_lshlrev_b32 v1, 2, v255
    global_load_dword v42, v1, s[64:65] offset:0
    global_load_dword v43, v1, s[64:65] offset:256
    global_load_dword v44, v1, s[64:65] offset:512
    global_load_dword v45, v1, s[64:65] offset:768
    global_load_dword v46, v1, s[64:65] offset:1024
    global_load_dword v47, v1, s[64:65] offset:1280
    global_load_dword v48, v1, s[64:65] offset:1536
    global_load_dword v49, v1, s[64:65] offset:1792
    global_load_dword v50, v1, s[64:65] offset:2048
    global_load_dword v51, v1, s[64:65] offset:2304
    global_load_dword v52, v1, s[64:65] offset:2560
    global_load_dword v53, v1, s[64:65] offset:2816
    global_load_dword v54, v1, s[64:65] offset:3072
    global_load_dword v55, v1, s[64:65] offset:3328
    global_load_dword v56, v1, s[64:65] offset:3584
    global_load_dword v57, v1, s[64:65] offset:3840
    v_add_u32 v1, 4096, v1
    global_load_dword v58, v1, s[64:65] offset:0
    global_load_dword v59, v1, s[64:65] offset:256
    v_lshrrev_b32 v1, 3, v255
    v_and_b32 v2, 7, v255
    v_add_u32 v3, 0, v1
    v_mul_u32_u24 v4, 171, v3
    v_lshrrev_b32 v4, 9, v4
    v_mul_u32_u24 v5, 3, v4
    v_sub_u32 v5, v3, v5
    v_lshlrev_b32 v5, 7, v5
    v_lshlrev_b32 v7, 1, v4
    v_and_b32 v7, 4, v7
    v_bfe_u32 v6, v4, 2, 2
    v_or_b32 v6, v6, v7
    v_xor_b32 v6, v6, v2
    v_lshl_add_u32 v5, v6, 4, v5
    v_mul_u32_u24 v4, 12288, v4
    v_add_u32 v4, v4, v5
    v_subrev_u32 v11, 0, v4
    v_add_u32 v17, 194560, v4
    v_mul_u32_u24 v4, 171, v3
    v_lshrrev_b32 v4, 9, v4
    v_and_b32 v4, 6, v4
    v_xor_b32 v4, v4, v2
    v_lshlrev_b32 v5, 7, v1
    v_lshl_add_u32 v8, v4, 4, v5
    v_add_u32 v3, 8, v1
    v_mul_u32_u24 v4, 171, v3
    v_lshrrev_b32 v4, 9, v4
    v_mul_u32_u24 v5, 3, v4
    v_sub_u32 v5, v3, v5
    v_lshlrev_b32 v5, 7, v5
    v_lshlrev_b32 v7, 1, v4
    v_and_b32 v7, 4, v7
    v_bfe_u32 v6, v4, 2, 2
    v_or_b32 v6, v6, v7
    v_xor_b32 v6, v6, v2
    v_lshl_add_u32 v5, v6, 4, v5
    v_mul_u32_u24 v4, 12288, v4
    v_add_u32 v4, v4, v5
    v_subrev_u32 v12, 1024, v4
    v_add_u32 v18, 193536, v4
    v_mul_u32_u24 v4, 171, v3
    v_lshrrev_b32 v4, 9, v4
    v_and_b32 v4, 6, v4
    v_xor_b32 v4, v4, v2
    v_lshlrev_b32 v5, 7, v1
    v_lshl_add_u32 v9, v4, 4, v5
    v_add_u32 v3, 16, v1
    v_mul_u32_u24 v4, 171, v3
    v_lshrrev_b32 v4, 9, v4
    v_mul_u32_u24 v5, 3, v4
    v_sub_u32 v5, v3, v5
    v_lshlrev_b32 v5, 7, v5
    v_lshlrev_b32 v7, 1, v4
    v_and_b32 v7, 4, v7
    v_bfe_u32 v6, v4, 2, 2
    v_or_b32 v6, v6, v7
    v_xor_b32 v6, v6, v2
    v_lshl_add_u32 v5, v6, 4, v5
    v_mul_u32_u24 v4, 12288, v4
    v_add_u32 v4, v4, v5
    v_subrev_u32 v13, 2048, v4
    v_add_u32 v19, 196608, v4
    v_mul_u32_u24 v4, 171, v3
    v_lshrrev_b32 v4, 9, v4
    v_and_b32 v4, 6, v4
    v_xor_b32 v4, v4, v2
    v_lshlrev_b32 v5, 7, v1
    v_lshl_add_u32 v10, v4, 4, v5
    v_add_u32 v3, 24, v1
    v_mul_u32_u24 v4, 171, v3
    v_lshrrev_b32 v4, 9, v4
    v_mul_u32_u24 v5, 3, v4
    v_sub_u32 v5, v3, v5
    v_lshlrev_b32 v5, 7, v5
    v_lshlrev_b32 v7, 1, v4
    v_and_b32 v7, 4, v7
    v_bfe_u32 v6, v4, 2, 2
    v_or_b32 v6, v6, v7
    v_xor_b32 v6, v6, v2
    v_lshl_add_u32 v5, v6, 4, v5
    v_mul_u32_u24 v4, 12288, v4
    v_add_u32 v4, v4, v5
    v_subrev_u32 v14, 3072, v4
    v_add_u32 v20, 195584, v4
    v_add_u32 v3, 32, v1
    v_mul_u32_u24 v4, 171, v3
    v_lshrrev_b32 v4, 9, v4
    v_mul_u32_u24 v5, 3, v4
    v_sub_u32 v5, v3, v5
    v_lshlrev_b32 v5, 7, v5
    v_lshlrev_b32 v7, 1, v4
    v_and_b32 v7, 4, v7
    v_bfe_u32 v6, v4, 2, 2
    v_or_b32 v6, v6, v7
    v_xor_b32 v6, v6, v2
    v_lshl_add_u32 v5, v6, 4, v5
    v_mul_u32_u24 v4, 12288, v4
    v_add_u32 v4, v4, v5
    v_subrev_u32 v15, 0, v4
    v_add_u32 v21, 194560, v4
    v_add_u32 v3, 40, v1
    v_mul_u32_u24 v4, 171, v3
    v_lshrrev_b32 v4, 9, v4
    v_mul_u32_u24 v5, 3, v4
    v_sub_u32 v5, v3, v5
    v_lshlrev_b32 v5, 7, v5
    v_lshlrev_b32 v7, 1, v4
    v_and_b32 v7, 4, v7
    v_bfe_u32 v6, v4, 2, 2
    v_or_b32 v6, v6, v7
    v_xor_b32 v6, v6, v2
    v_lshl_add_u32 v5, v6, 4, v5
    v_mul_u32_u24 v4, 12288, v4
    v_add_u32 v4, v4, v5
    v_subrev_u32 v16, 1024, v4
    v_add_u32 v22, 193536, v4
    v_add_u32 v3, 0, v1
    v_bfe_u32 v4, v3, 1, 3
    v_xor_b32 v4, v4, v2
    v_mul_u32_u24 v3, 1280, v3
    v_lshl_add_u32 v3, v4, 4, v3
    v_subrev_u32 v23, 0, v3
    v_add_u32 v25, 18432, v3
    v_add_u32 v3, 8, v1
    v_bfe_u32 v4, v3, 1, 3
    v_xor_b32 v4, v4, v2
    v_mul_u32_u24 v3, 1280, v3
    v_lshl_add_u32 v3, v4, 4, v3
    v_subrev_u32 v24, 1024, v3
    v_add_u32 v26, 17408, v3
    s_mul_i32 s90, s36, 384
    s_mul_i32 s91, s37, 122880
    s_mul_i32 s94, s50, 1966080
    s_mul_i32 s92, s36, 245760
    v_add_u32 v3, 0, v255
    v_mul_u32_u24 v4, 6554, v3
    v_lshrrev_b32 v4, 16, v4
    v_mul_u32_u24 v5, 10, v4
    v_sub_u32 v5, v3, v5
    v_mul_u32_u24 v4, 1280, v4
    v_lshl_add_u32 v4, v5, 4, v4
    v_subrev_u32 v27, 0, v4
    v_add_u32 v3, 64, v255
    v_mul_u32_u24 v4, 6554, v3
    v_lshrrev_b32 v4, 16, v4
    v_mul_u32_u24 v5, 10, v4
    v_sub_u32 v5, v3, v5
    v_mul_u32_u24 v4, 1280, v4
    v_lshl_add_u32 v4, v5, 4, v4
    v_subrev_u32 v28, 1024, v4
    v_add_u32 v3, 128, v255
    v_mul_u32_u24 v4, 6554, v3
    v_lshrrev_b32 v4, 16, v4
    v_mul_u32_u24 v5, 10, v4
    v_sub_u32 v5, v3, v5
    v_mul_u32_u24 v4, 1280, v4
    v_lshl_add_u32 v4, v5, 4, v4
    v_subrev_u32 v29, 2048, v4
    v_add_u32 v3, 192, v255
    v_mul_u32_u24 v4, 6554, v3
    v_lshrrev_b32 v4, 16, v4
    v_mul_u32_u24 v5, 10, v4
    v_sub_u32 v5, v3, v5
    v_mul_u32_u24 v4, 1280, v4
    v_lshl_add_u32 v4, v5, 4, v4
    v_subrev_u32 v30, 3072, v4
    v_add_u32 v3, 256, v255
    v_mul_u32_u24 v4, 6554, v3
    v_lshrrev_b32 v4, 16, v4
    v_mul_u32_u24 v5, 10, v4
    v_sub_u32 v5, v3, v5
    v_mul_u32_u24 v4, 1280, v4
    v_lshl_add_u32 v4, v5, 4, v4
    v_subrev_u32 v31, 0, v4
    v_min_u32 v5, 11, v255
    s_lshl_b32 s52, s37, 2
    v_mul_u32_u24 v2, 171, v5
    v_lshrrev_b32 v2, 9, v2
    v_mul_u32_u24 v3, 3, v2
    v_sub_u32 v3, v5, v3
    v_lshrrev_b32 v4, 2, v2
    v_and_b32 v2, 3, v2
    v_lshl_add_u32 v2, v4, 6, v2
    v_add_u32 v2, s52, v2
    v_mul_u32_u24 v2, 12288, v2
    v_lshl_add_u32 v35, v3, 7, v2
    v_min_u32 v3, 29, v255
    v_mul_u32_u24 v4, 52, v3
    v_lshrrev_b32 v4, 8, v4
    v_mul_u32_u24 v5, 5, v4
    v_sub_u32 v5, v3, v5
    v_and_b32 v6, 1, v4
    v_lshrrev_b32 v4, 1, v4
    v_mul_u32_u24 v6, 192, v6
    v_lshl_add_u32 v4, v4, 5, v6
    v_add_u32 v4, s41, v4
    v_mul_u32_u24 v4, 1280, v4
    v_lshl_add_u32 v36, v5, 7, v4
    s_lshr_b32 s53, s41, 4
    s_mul_i32 s53, s53, 48
    v_min_u32 v3, 47, v255
    v_add_u32 v3, s53, v3
    v_mul_u32_u24 v39, 1280, v3
    v_lshlrev_b32 v32, 4, v255
    v_add_u32 v37, 73728, v32
    s_lshl_b32 s60, s37, 5
    s_add_u32 s60, s60, s36
    s_mul_i32 s60, s60, 196608
    s_mov_b32 s55, 0
    s_add_u32 s67, s90, 0
    s_add_u32 s68, s91, 0
    s_mov_b32 s69, 110592
    s_add_u32 m0, s69, 0
    s_add_u32 s53, s67, 0
    buffer_load_dwordx4 v11, s[12:15], s53 offen offset:0  lds
    buffer_load_dwordx4 v12, s[12:15], s53 offen offset:1024  lds
    buffer_load_dwordx4 v13, s[12:15], s53 offen offset:2048  lds
    buffer_load_dwordx4 v14, s[12:15], s53 offen offset:3072  lds
    s_add_u32 m0, s69, 4096
    s_nop 0
    buffer_load_dwordx4 v15, s[12:15], s53 offen offset:0  lds
    buffer_load_dwordx4 v16, s[12:15], s53 offen offset:1024  lds
    buffer_load_dwordx4 v17, s[12:15], s53 offen offset:2048  lds
    buffer_load_dwordx4 v18, s[12:15], s53 offen offset:3072  lds
    s_add_u32 m0, s69, 8192
    s_nop 0
    buffer_load_dwordx4 v19, s[12:15], s53 offen offset:0  lds
    buffer_load_dwordx4 v20, s[12:15], s53 offen offset:1024  lds
    buffer_load_dwordx4 v21, s[12:15], s53 offen offset:2048  lds
    buffer_load_dwordx4 v22, s[12:15], s53 offen offset:3072  lds
    s_add_u32 m0, s69, 12288
    s_add_u32 s53, s67, 393216
    buffer_load_dwordx4 v11, s[12:15], s53 offen offset:0  lds
    buffer_load_dwordx4 v12, s[12:15], s53 offen offset:1024  lds
    buffer_load_dwordx4 v13, s[12:15], s53 offen offset:2048  lds
    buffer_load_dwordx4 v14, s[12:15], s53 offen offset:3072  lds
    s_add_u32 m0, s69, 16384
    s_nop 0
    buffer_load_dwordx4 v15, s[12:15], s53 offen offset:0  lds
    buffer_load_dwordx4 v16, s[12:15], s53 offen offset:1024  lds
    buffer_load_dwordx4 v17, s[12:15], s53 offen offset:2048  lds
    buffer_load_dwordx4 v18, s[12:15], s53 offen offset:3072  lds
    s_add_u32 m0, s69, 20480
    s_nop 0
    buffer_load_dwordx4 v19, s[12:15], s53 offen offset:0  lds
    buffer_load_dwordx4 v20, s[12:15], s53 offen offset:1024  lds
    buffer_load_dwordx4 v21, s[12:15], s53 offen offset:2048  lds
    buffer_load_dwordx4 v22, s[12:15], s53 offen offset:3072  lds
    s_add_u32 m0, s69, 24576
    s_add_u32 s53, s68, 0
    buffer_load_dwordx4 v23, s[20:23], s53 offen offset:0  lds
    buffer_load_dwordx4 v24, s[20:23], s53 offen offset:1024  lds
    buffer_load_dwordx4 v25, s[20:23], s53 offen offset:2048  lds
    buffer_load_dwordx4 v26, s[20:23], s53 offen offset:3072  lds
    s_add_u32 m0, s69, 28672
    s_add_u32 s53, s68, 40960
    buffer_load_dwordx4 v23, s[20:23], s53 offen offset:0  lds
    buffer_load_dwordx4 v24, s[20:23], s53 offen offset:1024  lds
    buffer_load_dwordx4 v25, s[20:23], s53 offen offset:2048  lds
    buffer_load_dwordx4 v26, s[20:23], s53 offen offset:3072  lds
    s_add_u32 m0, s69, 32768
    s_add_u32 s53, s68, 81920
    buffer_load_dwordx4 v23, s[20:23], s53 offen offset:0  lds
    buffer_load_dwordx4 v24, s[20:23], s53 offen offset:1024  lds
    buffer_load_dwordx4 v25, s[20:23], s53 offen offset:2048  lds
    buffer_load_dwordx4 v26, s[20:23], s53 offen offset:3072  lds
    s_add_u32 s67, s90, 786432
    s_add_u32 s68, s91, 128
    s_mov_b32 s69, 73728
    s_add_u32 m0, s69, 0
    s_add_u32 s53, s67, 0
    buffer_load_dwordx4 v11, s[12:15], s53 offen offset:0  lds
    buffer_load_dwordx4 v12, s[12:15], s53 offen offset:1024  lds
    buffer_load_dwordx4 v13, s[12:15], s53 offen offset:2048  lds
    buffer_load_dwordx4 v14, s[12:15], s53 offen offset:3072  lds
    s_add_u32 m0, s69, 4096
    s_nop 0
    buffer_load_dwordx4 v15, s[12:15], s53 offen offset:0  lds
    buffer_load_dwordx4 v16, s[12:15], s53 offen offset:1024  lds
    buffer_load_dwordx4 v17, s[12:15], s53 offen offset:2048  lds
    buffer_load_dwordx4 v18, s[12:15], s53 offen offset:3072  lds
    s_add_u32 m0, s69, 8192
    s_nop 0
    buffer_load_dwordx4 v19, s[12:15], s53 offen offset:0  lds
    buffer_load_dwordx4 v20, s[12:15], s53 offen offset:1024  lds
    buffer_load_dwordx4 v21, s[12:15], s53 offen offset:2048  lds
    buffer_load_dwordx4 v22, s[12:15], s53 offen offset:3072  lds
    s_add_u32 m0, s69, 12288
    s_add_u32 s53, s67, 393216
    buffer_load_dwordx4 v11, s[12:15], s53 offen offset:0  lds
    buffer_load_dwordx4 v12, s[12:15], s53 offen offset:1024  lds
    buffer_load_dwordx4 v13, s[12:15], s53 offen offset:2048  lds
    buffer_load_dwordx4 v14, s[12:15], s53 offen offset:3072  lds
    s_add_u32 m0, s69, 16384
    s_nop 0
    buffer_load_dwordx4 v15, s[12:15], s53 offen offset:0  lds
    buffer_load_dwordx4 v16, s[12:15], s53 offen offset:1024  lds
    buffer_load_dwordx4 v17, s[12:15], s53 offen offset:2048  lds
    buffer_load_dwordx4 v18, s[12:15], s53 offen offset:3072  lds
    s_add_u32 m0, s69, 20480
    s_nop 0
    buffer_load_dwordx4 v19, s[12:15], s53 offen offset:0  lds
    buffer_load_dwordx4 v20, s[12:15], s53 offen offset:1024  lds
    buffer_load_dwordx4 v21, s[12:15], s53 offen offset:2048  lds
    buffer_load_dwordx4 v22, s[12:15], s53 offen offset:3072  lds
    s_mov_b32 s69, 122880
    s_add_u32 m0, s69, 24576
    s_add_u32 s53, s68, 0
    buffer_load_dwordx4 v23, s[20:23], s53 offen offset:0  lds
    buffer_load_dwordx4 v24, s[20:23], s53 offen offset:1024  lds
    buffer_load_dwordx4 v25, s[20:23], s53 offen offset:2048  lds
    buffer_load_dwordx4 v26, s[20:23], s53 offen offset:3072  lds
    s_add_u32 m0, s69, 28672
    s_add_u32 s53, s68, 40960
    buffer_load_dwordx4 v23, s[20:23], s53 offen offset:0  lds
    buffer_load_dwordx4 v24, s[20:23], s53 offen offset:1024  lds
    buffer_load_dwordx4 v25, s[20:23], s53 offen offset:2048  lds
    buffer_load_dwordx4 v26, s[20:23], s53 offen offset:3072  lds
    s_add_u32 m0, s69, 32768
    s_add_u32 s53, s68, 81920
    buffer_load_dwordx4 v23, s[20:23], s53 offen offset:0  lds
    buffer_load_dwordx4 v24, s[20:23], s53 offen offset:1024  lds
    buffer_load_dwordx4 v25, s[20:23], s53 offen offset:2048  lds
    buffer_load_dwordx4 v26, s[20:23], s53 offen offset:3072  lds
    s_waitcnt vmcnt(63)
    s_cmp_eq_u32 s55, 64
    s_cbranch_scc1 LD_sw2
LD_swr2:
    v_readlane_b32 s66, v42, s55
    v_readlane_b32 s67, v44, s55
    v_readlane_b32 s68, v46, s55
    v_readlane_b32 s69, v48, s55
    v_readlane_b32 s70, v50, s55
    v_readlane_b32 s71, v52, s55
    v_readlane_b32 s72, v54, s55
    v_readlane_b32 s73, v56, s55
    v_readlane_b32 s74, v58, s55
    s_add_u32 s55, s55, 1
    s_bitcmp1_b32 s66, 1
    s_cselect_b32 s53, s92, s90
    s_add_u32 s67, s67, s53
    s_add_u32 s68, s68, s91
    s_bfe_u32 s77, s66, 0x40018
    s_waitcnt vmcnt(36)
LD_disp:
    s_cmp_eq_u32 s77, 0
    s_cbranch_scc1 LD_gen
    s_cmp_eq_u32 s77, 2
    s_cbranch_scc1 LD_fo
    s_cmp_eq_u32 s77, 3
    s_cbranch_scc1 LD_end
LD_fq:
    s_barrier
    s_add_u32 m0, s69, 0
    s_add_u32 s53, s67, 0
    buffer_load_dwordx4 v11, s[12:15], s53 offen offset:0  lds
    buffer_load_dwordx4 v12, s[12:15], s53 offen offset:1024  lds
    buffer_load_dwordx4 v13, s[12:15], s53 offen offset:2048  lds
    buffer_load_dwordx4 v14, s[12:15], s53 offen offset:3072  lds
    s_add_u32 m0, s69, 4096
    s_nop 0
    buffer_load_dwordx4 v15, s[12:15], s53 offen offset:0  lds
    buffer_load_dwordx4 v16, s[12:15], s53 offen offset:1024  lds
    buffer_load_dwordx4 v17, s[12:15], s53 offen offset:2048  lds
    buffer_load_dwordx4 v18, s[12:15], s53 offen offset:3072  lds
    s_add_u32 m0, s69, 8192
    s_nop 0
    buffer_load_dwordx4 v19, s[12:15], s53 offen offset:0  lds
    buffer_load_dwordx4 v20, s[12:15], s53 offen offset:1024  lds
    buffer_load_dwordx4 v21, s[12:15], s53 offen offset:2048  lds
    buffer_load_dwordx4 v22, s[12:15], s53 offen offset:3072  lds
    s_add_u32 m0, s69, 12288
    s_add_u32 s53, s67, 393216
    buffer_load_dwordx4 v11, s[12:15], s53 offen offset:0  lds
    buffer_load_dwordx4 v12, s[12:15], s53 offen offset:1024  lds
    buffer_load_dwordx4 v13, s[12:15], s53 offen offset:2048  lds
    buffer_load_dwordx4 v14, s[12:15], s53 offen offset:3072  lds
    s_add_u32 m0, s69, 16384
    s_nop 0
    buffer_load_dwordx4 v15, s[12:15], s53 offen offset:0  lds
    buffer_load_dwordx4 v16, s[12:15], s53 offen offset:1024  lds
    buffer_load_dwordx4 v17, s[12:15], s53 offen offset:2048  lds
    buffer_load_dwordx4 v18, s[12:15], s53 offen offset:3072  lds
    s_add_u32 m0, s69, 20480
    s_nop 0
    buffer_load_dwordx4 v19, s[12:15], s53 offen offset:0  lds
    buffer_load_dwordx4 v20, s[12:15], s53 offen offset:1024  lds
    buffer_load_dwordx4 v21, s[12:15], s53 offen offset:2048  lds
    buffer_load_dwordx4 v22, s[12:15], s53 offen offset:3072  lds
    s_add_u32 m0, s69, 24576
    s_add_u32 s53, s68, 0
    buffer_load_dwordx4 v23, s[20:23], s53 offen offset:0  lds
    buffer_load_dwordx4 v24, s[20:23], s53 offen offset:1024  lds
    buffer_load_dwordx4 v25, s[20:23], s53 offen offset:2048  lds
    buffer_load_dwordx4 v26, s[20:23], s53 offen offset:3072  lds
    s_add_u32 m0, s69, 28672
    s_add_u32 s53, s68, 40960
    buffer_load_dwordx4 v23, s[20:23], s53 offen offset:0  lds
    buffer_load_dwordx4 v24, s[20:23], s53 offen offset:1024  lds
    buffer_load_dwordx4 v25, s[20:23], s53 offen offset:2048  lds
    buffer_load_dwordx4 v26, s[20:23], s53 offen offset:3072  lds
    s_add_u32 m0, s69, 32768
    s_add_u32 s53, s68, 81920
    buffer_load_dwordx4 v23, s[20:23], s53 offen offset:0  lds
    buffer_load_dwordx4 v24, s[20:23], s53 offen offset:1024  lds
    buffer_load_dwordx4 v25, s[20:23], s53 offen offset:2048  lds
    buffer_load_dwordx4 v26, s[20:23], s53 offen offset:3072  lds
    s_cmp_eq_u32 s55, 64
    s_cbranch_scc1 LD_sw3
LD_swr3:
    v_readlane_b32 s66, v42, s55
    v_readlane_b32 s67, v44, s55
    v_readlane_b32 s68, v46, s55
    v_readlane_b32 s69, v48, s55
    s_add_u32 s55, s55, 1
    s_bitcmp1_b32 s66, 1
    s_cselect_b32 s53, s92, s90
    s_add_u32 s67, s67, s53
    s_add_u32 s68, s68, s91
    s_bfe_u32 s77, s66, 0x40018
    s_cmp_eq_u32 s77, 1
    s_cbranch_scc0 LD_fqx
    s_waitcnt vmcnt(36)
    s_branch LD_fq
LD_fqx:
    s_sub_u32 s53, s55, 1
    v_readlane_b32 s70, v50, s53
    v_readlane_b32 s71, v52, s53
    v_readlane_b32 s72, v54, s53
    v_readlane_b32 s73, v56, s53
    v_readlane_b32 s74, v58, s53
    s_waitcnt vmcnt(36)
    s_branch LD_disp
LD_fo:
    s_barrier
    s_add_u32 m0, s69, 0
    s_add_u32 s53, s67, 0
    buffer_load_dwordx4 v27, s[16:19], s53 offen offset:0 lds
    buffer_load_dwordx4 v28, s[16:19], s53 offen offset:1024 lds
    buffer_load_dwordx4 v29, s[16:19], s53 offen offset:2048 lds
    buffer_load_dwordx4 v30, s[16:19], s53 offen offset:3072 lds
    s_add_u32 m0, s69, 4096
    s_nop 0
    buffer_load_dwordx4 v31, s[16:19], s53 offen offset:0 lds
    s_add_u32 m0, s69, 5120
    s_add_u32 s53, s67, 160
    buffer_load_dwordx4 v27, s[16:19], s53 offen offset:0 lds
    buffer_load_dwordx4 v28, s[16:19], s53 offen offset:1024 lds
    buffer_load_dwordx4 v29, s[16:19], s53 offen offset:2048 lds
    buffer_load_dwordx4 v30, s[16:19], s53 offen offset:3072 lds
    s_add_u32 m0, s69, 9216
    s_nop 0
    buffer_load_dwordx4 v31, s[16:19], s53 offen offset:0 lds
    s_add_u32 m0, s69, 10240
    s_add_u32 s53, s67, 320
    buffer_load_dwordx4 v27, s[16:19], s53 offen offset:0 lds
    buffer_load_dwordx4 v28, s[16:19], s53 offen offset:1024 lds
    buffer_load_dwordx4 v29, s[16:19], s53 offen offset:2048 lds
    buffer_load_dwordx4 v30, s[16:19], s53 offen offset:3072 lds
    s_add_u32 m0, s69, 14336
    s_nop 0
    buffer_load_dwordx4 v31, s[16:19], s53 offen offset:0 lds
    s_add_u32 m0, s69, 15360
    s_add_u32 s53, s67, 480
    buffer_load_dwordx4 v27, s[16:19], s53 offen offset:0 lds
    buffer_load_dwordx4 v28, s[16:19], s53 offen offset:1024 lds
    buffer_load_dwordx4 v29, s[16:19], s53 offen offset:2048 lds
    buffer_load_dwordx4 v30, s[16:19], s53 offen offset:3072 lds
    s_add_u32 m0, s69, 19456
    s_nop 0
    buffer_load_dwordx4 v31, s[16:19], s53 offen offset:0 lds
    s_cmp_eq_u32 s55, 64
    s_cbranch_scc1 LD_sw4
LD_swr4:
    v_readlane_b32 s66, v42, s55
    v_readlane_b32 s67, v44, s55
    v_readlane_b32 s68, v46, s55
    v_readlane_b32 s69, v48, s55
    s_add_u32 s55, s55, 1
    s_bitcmp1_b32 s66, 1
    s_cselect_b32 s53, s92, s90
    s_add_u32 s67, s67, s53
    s_add_u32 s68, s68, s91
    s_bfe_u32 s77, s66, 0x40018
    s_cmp_eq_u32 s77, 2
    s_waitcnt vmcnt(20)
    s_cbranch_scc1 LD_fo
    s_branch LD_disp
LD_gen:
    s_add_u32 s70, s70, s60
    s_add_u32 s71, s71, s60
    s_add_u32 s72, s72, s91
    s_add_u32 s73, s73, s90
    s_add_u32 s74, s74, s94
    s_bfe_u32 s76, s66, 0x20014
    s_mul_i32 s76, s76, 24576
    s_bitcmp1_b32 s66, 15
    s_cbranch_scc0 LD_nobar
LD_bar:
    s_barrier
LD_nobar:
    s_bitcmp1_b32 s66, 8
    s_cbranch_scc1 LD_misc
LD_nomisc:
    s_bitcmp1_b32 s66, 1
    s_cbranch_scc1 LD_o
    s_bitcmp1_b32 s66, 0
    s_cbranch_scc0 LD_t
    s_add_u32 m0, s69, 0
    s_add_u32 s53, s67, 0
    buffer_load_dwordx4 v11, s[12:15], s53 offen offset:0  lds
    buffer_load_dwordx4 v12, s[12:15], s53 offen offset:1024  lds
    buffer_load_dwordx4 v13, s[12:15], s53 offen offset:2048  lds
    buffer_load_dwordx4 v14, s[12:15], s53 offen offset:3072  lds
    s_add_u32 m0, s69, 4096
    s_nop 0
    buffer_load_dwordx4 v15, s[12:15], s53 offen offset:0  lds
    buffer_load_dwordx4 v16, s[12:15], s53 offen offset:1024  lds
    buffer_load_dwordx4 v17, s[12:15], s53 offen offset:2048  lds
    buffer_load_dwordx4 v18, s[12:15], s53 offen offset:3072  lds
    s_add_u32 m0, s69, 8192
    s_nop 0
    buffer_load_dwordx4 v19, s[12:15], s53 offen offset:0  lds
    buffer_load_dwordx4 v20, s[12:15], s53 offen offset:1024  lds
    buffer_load_dwordx4 v21, s[12:15], s53 offen offset:2048  lds
    buffer_load_dwordx4 v22, s[12:15], s53 offen offset:3072  lds
    s_add_u32 m0, s69, 12288
    s_add_u32 s53, s67, 393216
    buffer_load_dwordx4 v11, s[12:15], s53 offen offset:0  lds
    buffer_load_dwordx4 v12, s[12:15], s53 offen offset:1024  lds
    buffer_load_dwordx4 v13, s[12:15], s53 offen offset:2048  lds
    buffer_load_dwordx4 v14, s[12:15], s53 offen offset:3072  lds
    s_add_u32 m0, s69, 16384
    s_nop 0
    buffer_load_dwordx4 v15, s[12:15], s53 offen offset:0  lds
    buffer_load_dwordx4 v16, s[12:15], s53 offen offset:1024  lds
    buffer_load_dwordx4 v17, s[12:15], s53 offen offset:2048  lds
    buffer_load_dwordx4 v18, s[12:15], s53 offen offset:3072  lds
    s_add_u32 m0, s69, 20480
    s_nop 0
    buffer_load_dwordx4 v19, s[12:15], s53 offen offset:0  lds
    buffer_load_dwordx4 v20, s[12:15], s53 offen offset:1024  lds
    buffer_load_dwordx4 v21, s[12:15], s53 offen offset:2048  lds
    buffer_load_dwordx4 v22, s[12:15], s53 offen offset:3072  lds
    s_bitcmp1_b32 s66, 23
    s_cbranch_scc1 LD_t
    s_add_u32 m0, s69, 24576
    s_add_u32 s53, s68, 0
    buffer_load_dwordx4 v23, s[20:23], s53 offen offset:0  lds
    buffer_load_dwordx4 v24, s[20:23], s53 offen offset:1024  lds
    buffer_load_dwordx4 v25, s[20:23], s53 offen offset:2048  lds
    buffer_load_dwordx4 v26, s[20:23], s53 offen offset:3072  lds
    s_add_u32 m0, s69, 28672
    s_add_u32 s53, s68, 40960
    buffer_load_dwordx4 v23, s[20:23], s53 offen offset:0  lds
    buffer_load_dwordx4 v24, s[20:23], s53 offen offset:1024  lds
    buffer_load_dwordx4 v25, s[20:23], s53 offen offset:2048  lds
    buffer_load_dwordx4 v26, s[20:23], s53 offen offset:3072  lds
    s_add_u32 m0, s69, 32768
    s_add_u32 s53, s68, 81920
    buffer_load_dwordx4 v23, s[20:23], s53 offen offset:0  lds
    buffer_load_dwordx4 v24, s[20:23], s53 offen offset:1024  lds
    buffer_load_dwordx4 v25, s[20:23], s53 offen offset:2048  lds
    buffer_load_dwordx4 v26, s[20:23], s53 offen offset:3072  lds
    s_branch LD_t
LD_o:
    s_add_u32 m0, s69, 0
    s_add_u32 s53, s67, 0
    buffer_load_dwordx4 v27, s[16:19], s53 offen offset:0 lds
    buffer_load_dwordx4 v28, s[16:19], s53 offen offset:1024 lds
    buffer_load_dwordx4 v29, s[16:19], s53 offen offset:2048 lds
    buffer_load_dwordx4 v30, s[16:19], s53 offen offset:3072 lds
    s_add_u32 m0, s69, 4096
    s_nop 0
    buffer_load_dwordx4 v31, s[16:19], s53 offen offset:0 lds
    s_add_u32 m0, s69, 5120
    s_add_u32 s53, s67, 160
    buffer_load_dwordx4 v27, s[16:19], s53 offen offset:0 lds
    buffer_load_dwordx4 v28, s[16:19], s53 offen offset:1024 lds
    buffer_load_dwordx4 v29, s[16:19], s53 offen offset:2048 lds
    buffer_load_dwordx4 v30, s[16:19], s53 offen offset:3072 lds
    s_add_u32 m0, s69, 9216
    s_nop 0
    buffer_load_dwordx4 v31, s[16:19], s53 offen offset:0 lds
    s_add_u32 m0, s69, 10240
    s_add_u32 s53, s67, 320
    buffer_load_dwordx4 v27, s[16:19], s53 offen offset:0 lds
    buffer_load_dwordx4 v28, s[16:19], s53 offen offset:1024 lds
    buffer_load_dwordx4 v29, s[16:19], s53 offen offset:2048 lds
    buffer_load_dwordx4 v30, s[16:19], s53 offen offset:3072 lds
    s_add_u32 m0, s69, 14336
    s_nop 0
    buffer_load_dwordx4 v31, s[16:19], s53 offen offset:0 lds
    s_add_u32 m0, s69, 15360
    s_add_u32 s53, s67, 480
    buffer_load_dwordx4 v27, s[16:19], s53 offen offset:0 lds
    buffer_load_dwordx4 v28, s[16:19], s53 offen offset:1024 lds
    buffer_load_dwordx4 v29, s[16:19], s53 offen offset:2048 lds
    buffer_load_dwordx4 v30, s[16:19], s53 offen offset:3072 lds
    s_add_u32 m0, s69, 19456
    s_nop 0
    buffer_load_dwordx4 v31, s[16:19], s53 offen offset:0 lds
LD_t:
    s_and_b32 s53, s66, 0x7c
    s_cbranch_scc0 LD_nov
    s_bitcmp1_b32 s66, 5
    s_cbranch_scc0 LD_nt1
    buffer_load_dword v38, v35, s[12:15], s73 offen
LD_nt1:
    s_bitcmp1_b32 s66, 6
    s_cbranch_scc0 LD_nt2
    buffer_load_dword v38, v36, s[16:19], s74 offen
LD_nt2:
    s_bitcmp1_b32 s66, 2
    s_cbranch_scc0 LD_nok
    s_add_u32 m0, s76, 0
    s_add_u32 s53, s70, 0
    buffer_load_dwordx4 v8, s[4:7], s53 offen offset:0 nt lds
    buffer_load_dwordx4 v9, s[4:7], s53 offen offset:1024 nt lds
    buffer_load_dwordx4 v10, s[4:7], s53 offen offset:2048 nt lds
    buffer_load_dwordx4 v8, s[4:7], s53 offen offset:3072 nt lds
    s_add_u32 m0, s76, 4096
    s_add_u32 s53, s70, 4096
    buffer_load_dwordx4 v9, s[4:7], s53 offen offset:0 nt lds
    buffer_load_dwordx4 v10, s[4:7], s53 offen offset:1024 nt lds
    buffer_load_dwordx4 v8, s[4:7], s53 offen offset:2048 nt lds
    buffer_load_dwordx4 v9, s[4:7], s53 offen offset:3072 nt lds
    s_add_u32 m0, s76, 8192
    s_add_u32 s53, s70, 8192
    buffer_load_dwordx4 v10, s[4:7], s53 offen offset:0 nt lds
    buffer_load_dwordx4 v8, s[4:7], s53 offen offset:1024 nt lds
    buffer_load_dwordx4 v9, s[4:7], s53 offen offset:2048 nt lds
    buffer_load_dwordx4 v10, s[4:7], s53 offen offset:3072 nt lds
LD_nok:
    s_bitcmp1_b32 s66, 3
    s_cbranch_scc0 LD_nov
    s_add_u32 m0, s76, 12288
    s_add_u32 s53, s71, 0
    buffer_load_dwordx4 v8, s[8:11], s53 offen offset:0 nt lds
    buffer_load_dwordx4 v9, s[8:11], s53 offen offset:1024 nt lds
    buffer_load_dwordx4 v10, s[8:11], s53 offen offset:2048 nt lds
    buffer_load_dwordx4 v8, s[8:11], s53 offen offset:3072 nt lds
    s_add_u32 m0, s76, 16384
    s_add_u32 s53, s71, 4096
    buffer_load_dwordx4 v9, s[8:11], s53 offen offset:0 nt lds
    buffer_load_dwordx4 v10, s[8:11], s53 offen offset:1024 nt lds
    buffer_load_dwordx4 v8, s[8:11], s53 offen offset:2048 nt lds
    buffer_load_dwordx4 v9, s[8:11], s53 offen offset:3072 nt lds
    s_add_u32 m0, s76, 20480
    s_add_u32 s53, s71, 8192
    buffer_load_dwordx4 v10, s[8:11], s53 offen offset:0 nt lds
    buffer_load_dwordx4 v8, s[8:11], s53 offen offset:1024 nt lds
    buffer_load_dwordx4 v9, s[8:11], s53 offen offset:2048 nt lds
    buffer_load_dwordx4 v10, s[8:11], s53 offen offset:3072 nt lds
    s_bitcmp1_b32 s66, 10
    s_cbranch_scc1 LD_uns
LD_unsr:
LD_nov:
    s_mov_b32 s62, s66
    s_cmp_eq_u32 s55, 64
    s_cbranch_scc1 LD_sw5
LD_swr5:
    v_readlane_b32 s66, v42, s55
    v_readlane_b32 s67, v44, s55
    v_readlane_b32 s68, v46, s55
    v_readlane_b32 s69, v48, s55
    v_readlane_b32 s70, v50, s55
    v_readlane_b32 s71, v52, s55
    v_readlane_b32 s72, v54, s55
    v_readlane_b32 s73, v56, s55
    v_readlane_b32 s74, v58, s55
    s_add_u32 s55, s55, 1
    s_bitcmp1_b32 s66, 1
    s_cselect_b32 s53, s92, s90
    s_add_u32 s67, s67, s53
    s_add_u32 s68, s68, s91
    s_bfe_u32 s77, s66, 0x40018
    s_bitcmp1_b32 s62, 13
    s_cbranch_scc0 LD_gen
    s_add_u32 s70, s70, s60
    s_add_u32 s71, s71, s60
    s_add_u32 s72, s72, s91
    s_add_u32 s73, s73, s90
    s_add_u32 s74, s74, s94
    s_bfe_u32 s76, s66, 0x20014
    s_mul_i32 s76, s76, 24576
    s_waitcnt lgkmcnt(0)
    s_bfe_u32 s53, s62, 0x40010
    s_cmp_eq_u32 s53, 1
    s_cbranch_scc1 LD_w1
    s_cmp_eq_u32 s53, 2
    s_cbranch_scc1 LD_w2
    s_cmp_eq_u32 s53, 3
    s_cbranch_scc1 LD_w3
    s_cmp_eq_u32 s53, 4
    s_cbranch_scc1 LD_w4
    s_cmp_eq_u32 s53, 5
    s_cbranch_scc1 LD_w5
    s_cmp_eq_u32 s77, 0
    s_waitcnt vmcnt(23)
    s_cbranch_scc1 LD_bar
    s_branch LD_disp
LD_end:
    s_endpgm
LD_sw2:
    v_mov_b32 v42, v43
    v_mov_b32 v44, v45
    v_mov_b32 v46, v47
    v_mov_b32 v48, v49
    v_mov_b32 v50, v51
    v_mov_b32 v52, v53
    v_mov_b32 v54, v55
    v_mov_b32 v56, v57
    v_mov_b32 v58, v59
    s_branch LD_swr2
LD_sw3:
    v_mov_b32 v42, v43
    v_mov_b32 v44, v45
    v_mov_b32 v46, v47
    v_mov_b32 v48, v49
    v_mov_b32 v50, v51
    v_mov_b32 v52, v53
    v_mov_b32 v54, v55
    v_mov_b32 v56, v57
    v_mov_b32 v58, v59
    s_branch LD_swr3
LD_sw4:
    v_mov_b32 v42, v43
    v_mov_b32 v44, v45
    v_mov_b32 v46, v47
    v_mov_b32 v48, v49
    v_mov_b32 v50, v51
    v_mov_b32 v52, v53
    v_mov_b32 v54, v55
    v_mov_b32 v56, v57
    v_mov_b32 v58, v59
    s_branch LD_swr4
LD_misc:
    ds_read_b128 v[60:63], v37 offset:0
    ds_read_b128 v[64:67], v37 offset:1024
    ds_read_b128 v[68:71], v37 offset:2048
    ds_read_b128 v[72:75], v37 offset:3072
    ds_read_b128 v[76:79], v37 offset:4096
    ds_read_b128 v[80:83], v37 offset:5120
    ds_read_b128 v[84:87], v37 offset:6144
    ds_read_b128 v[88:91], v37 offset:7168
    ds_read_b128 v[92:95], v37 offset:8192
    ds_read_b128 v[96:99], v37 offset:9216
    ds_read_b128 v[100:103], v37 offset:10240
    ds_read_b128 v[104:107], v37 offset:11264
    s_waitcnt lgkmcnt(6)
    ds_read_b128 v[108:111], v37 offset:12288
    ds_read_b128 v[112:115], v37 offset:13312
    ds_read_b128 v[116:119], v37 offset:14336
    ds_read_b128 v[120:123], v37 offset:15360
    ds_read_b128 v[124:127], v37 offset:16384
    ds_read_b128 v[128:131], v37 offset:17408
    s_waitcnt lgkmcnt(6)
    ds_read_b128 v[132:135], v37 offset:18432
    ds_read_b128 v[136:139], v37 offset:19456
    ds_read_b128 v[140:143], v37 offset:20480
    ds_read_b128 v[144:147], v37 offset:21504
    ds_read_b128 v[148:151], v37 offset:22528
    ds_read_b128 v[152:155], v37 offset:23552
    s_waitcnt lgkmcnt(6)
    ds_read_b128 v[156:159], v37 offset:24576
    ds_read_b128 v[160:163], v37 offset:25600
    ds_read_b128 v[164:167], v37 offset:26624
    ds_read_b128 v[168:171], v37 offset:27648
    ds_read_b128 v[172:175], v37 offset:28672
    ds_read_b128 v[176:179], v37 offset:29696
    s_waitcnt lgkmcnt(6)
    ds_read_b128 v[180:183], v37 offset:30720
    ds_read_b128 v[184:187], v37 offset:31744
    ds_read_b128 v[188:191], v37 offset:32768
    ds_read_b128 v[192:195], v37 offset:33792
    ds_read_b128 v[196:199], v37 offset:34816
    ds_read_b128 v[200:203], v37 offset:35840
    s_waitcnt lgkmcnt(0)
    s_branch LD_nomisc
LD_uns:
    s_sub_u32 s53, s68, s91
    v_add_u32 v7, s53, v32
    s_bfe_u32 s53, s66, 0x3001c
    s_cmp_eq_u32 s53, 1
    s_cbranch_scc1 LD_u1
    s_cmp_eq_u32 s53, 2
    s_cbranch_scc1 LD_u2
    s_cmp_eq_u32 s53, 3
    s_cbranch_scc1 LD_u3
    s_cmp_eq_u32 s53, 4
    s_cbranch_scc1 LD_u4
    s_cmp_eq_u32 s53, 5
    s_cbranch_scc1 LD_u5
LD_u0:
    ds_write_b128 v7, v[60:63] offset:0
    ds_write_b128 v7, v[64:67] offset:1024
    ds_write_b128 v7, v[68:71] offset:2048
    ds_write_b128 v7, v[72:75] offset:3072
    ds_write_b128 v7, v[76:79] offset:4096
    ds_write_b128 v7, v[80:83] offset:5120
    s_branch LD_unsr
LD_u1:
    ds_write_b128 v7, v[84:87] offset:0
    ds_write_b128 v7, v[88:91] offset:1024
    ds_write_b128 v7, v[92:95] offset:2048
    ds_write_b128 v7, v[96:99] offset:3072
    ds_write_b128 v7, v[100:103] offset:4096
    ds_write_b128 v7, v[104:107] offset:5120
    s_branch LD_unsr
LD_u2:
    ds_write_b128 v7, v[108:111] offset:0
    ds_write_b128 v7, v[112:115] offset:1024
    ds_write_b128 v7, v[116:119] offset:2048
    ds_write_b128 v7, v[120:123] offset:3072
    ds_write_b128 v7, v[124:127] offset:4096
    ds_write_b128 v7, v[128:131] offset:5120
    s_branch LD_unsr
LD_u3:
    ds_write_b128 v7, v[132:135] offset:0
    ds_write_b128 v7, v[136:139] offset:1024
    ds_write_b128 v7, v[140:143] offset:2048
    ds_write_b128 v7, v[144:147] offset:3072
    ds_write_b128 v7, v[148:151] offset:4096
    ds_write_b128 v7, v[152:155] offset:5120
    s_branch LD_unsr
LD_u4:
    ds_write_b128 v7, v[156:159] offset:0
    ds_write_b128 v7, v[160:163] offset:1024
    ds_write_b128 v7, v[164:167] offset:2048
    ds_write_b128 v7, v[168:171] offset:3072
    ds_write_b128 v7, v[172:175] offset:4096
    ds_write_b128 v7, v[176:179] offset:5120
    s_branch LD_unsr
LD_u5:
    ds_write_b128 v7, v[180:183] offset:0
    ds_write_b128 v7, v[184:187] offset:1024
    ds_write_b128 v7, v[188:191] offset:2048
    ds_write_b128 v7, v[192:195] offset:3072
    ds_write_b128 v7, v[196:199] offset:4096
    ds_write_b128 v7, v[200:203] offset:5120
    s_branch LD_unsr
LD_sw5:
    v_mov_b32 v42, v43
    v_mov_b32 v44, v45
    v_mov_b32 v46, v47
    v_mov_b32 v48, v49
    v_mov_b32 v50, v51
    v_mov_b32 v52, v53
    v_mov_b32 v54, v55
    v_mov_b32 v56, v57
    v_mov_b32 v58, v59
    s_branch LD_swr5
LD_w1:
    s_cmp_eq_u32 s77, 0
    s_waitcnt vmcnt(0)
    s_cbranch_scc1 LD_bar
    s_branch LD_disp
LD_w2:
    s_cmp_eq_u32 s77, 0
    s_waitcnt vmcnt(20)
    s_cbranch_scc1 LD_bar
    s_branch LD_disp
LD_w3:
    s_cmp_eq_u32 s77, 0
    s_waitcnt vmcnt(13)
    s_cbranch_scc1 LD_bar
    s_branch LD_disp
LD_w4:
    s_cmp_eq_u32 s77, 0
    s_waitcnt vmcnt(25)
    s_cbranch_scc1 LD_bar
    s_branch LD_disp
LD_w5:
    s_cmp_eq_u32 s77, 0
    s_waitcnt vmcnt(24)
    s_cbranch_scc1 LD_bar
    s_branch LD_disp
L_proj:
    s_setprio 1
    s_getpc_b64 s[64:65]
TB_6:
    s_add_u32 s64, s64, L_table-TB_6
    s_addc_u32 s65, s65, 0
    v_lshlrev_b32 v1, 2, v255
    v_add_u32 v1, 4096, v1
    global_load_dword v251, v1, s[64:65] offset:512
    global_load_dword v252, v1, s[64:65] offset:768
    s_sub_u32 s46, s3, 4
    s_mov_b32 s62, 0x3dd53b95
    s_mov_b32 s63, 0x3dd53b95
    v_lshrrev_b32 v1, 4, v255
    v_bfe_u32 v2, v255, 2, 2
    v_bfe_u32 v3, v255, 1, 1
    v_and_b32 v4, 1, v255
    v_and_b32 v5, 15, v255
    v_lshl_add_u32 v6, v1, 3, v2
    v_mul_u32_u24 v6, 384, v6
    v_lshl_add_u32 v6, v4, 3, v6
    v_bfe_u32 v7, v255, 3, 1
    v_lshlrev_b32 v7, 2, v7
    v_and_b32 v8, 1, v1
    v_lshl_add_u32 v7, v8, 1, v7
    s_mul_i32 s47, s46, 3
    s_add_u32 s48, s47, 0
    s_lshr_b32 s64, s48, 1
    s_mul_i32 s64, s64, 6144
    s_and_b32 s49, s48, 1
    s_lshl_b32 s49, s49, 9
    s_add_u32 s64, s64, s49
    s_and_b32 s49, s48, 3
    s_lshl_b32 s49, s49, 1
    s_lshr_b32 s48, s48, 2
    s_lshl_b32 s48, s48, 7
    s_add_u32 s48, s48, 110592
    v_add_u32 v9, s49, v3
    v_add_u32 v10, 0, v7
    v_xor_b32 v9, v9, v10
    v_lshl_add_u32 v9, v9, 4, v6
    v_add_u32 v9, 0, v9
    v_add_u32 v144, s48, v9
    v_add_u32 v9, s49, v3
    v_add_u32 v10, 1, v7
    v_xor_b32 v9, v9, v10
    v_lshl_add_u32 v9, v9, 4, v6
    v_add_u32 v9, 1536, v9
    v_add_u32 v145, s48, v9
    s_add_u32 s48, s47, 1
    s_lshr_b32 s65, s48, 1
    s_mul_i32 s65, s65, 6144
    s_and_b32 s49, s48, 1
    s_lshl_b32 s49, s49, 9
    s_add_u32 s65, s65, s49
    s_and_b32 s49, s48, 3
    s_lshl_b32 s49, s49, 1
    s_lshr_b32 s48, s48, 2
    s_lshl_b32 s48, s48, 7
    s_add_u32 s48, s48, 110592
    v_add_u32 v9, s49, v3
    v_add_u32 v10, 0, v7
    v_xor_b32 v9, v9, v10
    v_lshl_add_u32 v9, v9, 4, v6
    v_add_u32 v9, 0, v9
    v_add_u32 v146, s48, v9
    v_add_u32 v9, s49, v3
    v_add_u32 v10, 1, v7
    v_xor_b32 v9, v9, v10
    v_lshl_add_u32 v9, v9, 4, v6
    v_add_u32 v9, 1536, v9
    v_add_u32 v147, s48, v9
    s_add_u32 s48, s47, 2
    s_lshr_b32 s66, s48, 1
    s_mul_i32 s66, s66, 6144
    s_and_b32 s49, s48, 1
    s_lshl_b32 s49, s49, 9
    s_add_u32 s66, s66, s49
    s_and_b32 s49, s48, 3
    s_lshl_b32 s49, s49, 1
    s_lshr_b32 s48, s48, 2
    s_lshl_b32 s48, s48, 7
    s_add_u32 s48, s48, 110592
    v_add_u32 v9, s49, v3
    v_add_u32 v10, 0, v7
    v_xor_b32 v9, v9, v10
    v_lshl_add_u32 v9, v9, 4, v6
    v_add_u32 v9, 0, v9
    v_add_u32 v148, s48, v9
    v_add_u32 v9, s49, v3
    v_add_u32 v10, 1, v7
    v_xor_b32 v9, v9, v10
    v_lshl_add_u32 v9, v9, 4, v6
    v_add_u32 v9, 1536, v9
    v_add_u32 v149, s48, v9
    v_add_u32 v9, 0, v1
    v_lshrrev_b32 v10, 1, v5
    v_xor_b32 v9, v9, v10
    v_lshlrev_b32 v10, 7, v5
    v_lshl_add_u32 v9, v9, 4, v10
    v_add_u32 v150, 135168, v9
    v_add_u32 v9, 4, v1
    v_lshrrev_b32 v10, 1, v5
    v_xor_b32 v9, v9, v10
    v_lshlrev_b32 v10, 7, v5
    v_lshl_add_u32 v9, v9, 4, v10
    v_add_u32 v151, 135168, v9
    v_lshlrev_b32 v9, 4, v255
    v_add_u32 v248, 73728, v9
    v_lshl_add_u32 v9, v1, 2, v2
    v_mul_u32_u24 v9, 160, v9
    v_and_b32 v10, 3, v255
    v_lshl_add_u32 v9, v10, 3, v9
    s_mul_i32 s48, s46, 5120
    s_add_u32 s48, s48, 110592
    v_add_u32 v249, s48, v9
    v_lshrrev_b32 v9, 1, v1
    v_lshl_add_u32 v9, v9, 4, v5
    v_lshlrev_b32 v9, 4, v9
    v_lshl_add_u32 v9, v8, 3, v9
    v_add_u32 v9, 73728, v9
    v_add_u32 v250, s64, v9
    s_sub_u32 s67, s64, s66
    s_sub_u32 s66, s66, s65
    s_sub_u32 s65, s65, s64
    s_lshl_b32 s68, s38, 4
    s_add_u32 s68, s68, s37
    s_mul_i32 s68, s68, 1114112
    s_lshl_b32 s49, s39, 10
    s_add_u32 s68, s68, s49
    s_mul_i32 s49, s46, 139264
    s_add_u32 s68, s68, s49
    s_add_u32 s68, s68, 38797312
    v_lshlrev_b32 v212, 4, v255
    s_mov_b32 s55, 0
    s_waitcnt vmcnt(0)
    v_readlane_b32 s53, v251, s55
    s_add_u32 s55, s55, 1
    s_cmp_eq_u32 s55, 64
    s_cbranch_scc1 P_sw7
P_swr7:
    s_bfe_i32 s54, s53, 0x9000e
    s_lshl_b32 s54, s54, 10
    s_ashr_i32 s57, s53, 23
    s_lshl_b32 s57, s57, 10
    s_and_b32 s56, s53, 7
P_disp:
    s_cmp_eq_u32 s56, 0
    s_cbranch_scc1 P_gen
    s_cmp_eq_u32 s56, 2
    s_cbranch_scc1 P_oo
    s_cmp_eq_u32 s56, 3
    s_cbranch_scc1 P_end
    s_cmp_eq_u32 s56, 4
    s_cbranch_scc1 P_qf
    s_cmp_eq_u32 s56, 5
    s_cbranch_scc1 P_qw
P_qq:
    s_barrier
    v_mfma_f32_16x16x32_bf16 v[0:3], v[108:111], v[120:123], v[0:3]
    ds_read_b64_tr_b16 v[72:73], v144 offset:0
    v_mfma_f32_16x16x32_bf16 v[24:27], v[112:115], v[120:123], v[24:27]
    ds_read_b64_tr_b16 v[74:75], v145 offset:0
    v_mfma_f32_16x16x32_bf16 v[48:51], v[116:119], v[120:123], v[48:51]
    ds_read_b128 v[84:87], v150 offset:0
    v_mfma_f32_16x16x32_bf16 v[52:55], v[116:119], v[124:127], v[52:55]
    ds_read_b64_tr_b16 v[76:77], v146 offset:0
    v_mfma_f32_16x16x32_bf16 v[28:31], v[112:115], v[124:127], v[28:31]
    ds_read_b64_tr_b16 v[78:79], v147 offset:0
    v_mfma_f32_16x16x32_bf16 v[4:7], v[108:111], v[124:127], v[4:7]
    ds_read_b64_tr_b16 v[80:81], v148 offset:0
    v_mfma_f32_16x16x32_bf16 v[8:11], v[108:111], v[128:131], v[8:11]
    ds_read_b64_tr_b16 v[82:83], v149 offset:0
    v_mfma_f32_16x16x32_bf16 v[32:35], v[112:115], v[128:131], v[32:35]
    ds_read_b128 v[88:91], v150 offset:2048
    v_mfma_f32_16x16x32_bf16 v[56:59], v[116:119], v[128:131], v[56:59]
    ds_read_b128 v[92:95], v150 offset:4096
    v_mfma_f32_16x16x32_bf16 v[60:63], v[116:119], v[132:135], v[60:63]
    ds_read_b128 v[96:99], v150 offset:6144
    v_mfma_f32_16x16x32_bf16 v[36:39], v[112:115], v[132:135], v[36:39]
    ds_read_b128 v[100:103], v150 offset:8192
    v_mfma_f32_16x16x32_bf16 v[12:15], v[108:111], v[132:135], v[12:15]
    ds_read_b128 v[104:107], v150 offset:10240
    v_mfma_f32_16x16x32_bf16 v[16:19], v[108:111], v[136:139], v[16:19]
    v_mfma_f32_16x16x32_bf16 v[40:43], v[112:115], v[136:139], v[40:43]
    v_mfma_f32_16x16x32_bf16 v[64:67], v[116:119], v[136:139], v[64:67]
    v_mfma_f32_16x16x32_bf16 v[68:71], v[116:119], v[140:143], v[68:71]
    v_mfma_f32_16x16x32_bf16 v[44:47], v[112:115], v[140:143], v[44:47]
    v_mfma_f32_16x16x32_bf16 v[20:23], v[108:111], v[140:143], v[20:23]
    s_waitcnt lgkmcnt(9)
    v_mfma_f32_16x16x32_bf16 v[0:3], v[72:75], v[84:87], v[0:3]
    ds_read_b64_tr_b16 v[108:109], v144 offset:12288
    ds_read_b64_tr_b16 v[110:111], v145 offset:12288
    s_waitcnt lgkmcnt(9)
    v_mfma_f32_16x16x32_bf16 v[24:27], v[76:79], v[84:87], v[24:27]
    ds_read_b64_tr_b16 v[112:113], v146 offset:12288
    ds_read_b64_tr_b16 v[114:115], v147 offset:12288
    s_waitcnt lgkmcnt(9)
    v_mfma_f32_16x16x32_bf16 v[48:51], v[80:83], v[84:87], v[48:51]
    ds_read_b64_tr_b16 v[116:117], v148 offset:12288
    ds_read_b64_tr_b16 v[118:119], v149 offset:12288
    s_waitcnt lgkmcnt(10)
    v_mfma_f32_16x16x32_bf16 v[52:55], v[80:83], v[88:91], v[52:55]
    ds_read_b128 v[120:123], v151 offset:0
    ds_read_b128 v[124:127], v151 offset:2048
    v_mfma_f32_16x16x32_bf16 v[28:31], v[76:79], v[88:91], v[28:31]
    ds_read_b128 v[128:131], v151 offset:4096
    ds_read_b128 v[132:135], v151 offset:6144
    v_mfma_f32_16x16x32_bf16 v[4:7], v[72:75], v[88:91], v[4:7]
    ds_read_b128 v[136:139], v151 offset:8192
    s_waitcnt lgkmcnt(14)
    ds_read_b128 v[140:143], v151 offset:10240
    v_mfma_f32_16x16x32_bf16 v[8:11], v[72:75], v[92:95], v[8:11]
    v_add_u32 v144, s54, v144
    v_add_u32 v145, s54, v145
    v_mfma_f32_16x16x32_bf16 v[32:35], v[76:79], v[92:95], v[32:35]
    v_add_u32 v146, s54, v146
    v_add_u32 v147, s54, v147
    v_mfma_f32_16x16x32_bf16 v[56:59], v[80:83], v[92:95], v[56:59]
    v_add_u32 v148, s54, v148
    v_add_u32 v149, s54, v149
    s_waitcnt lgkmcnt(14)
    v_mfma_f32_16x16x32_bf16 v[60:63], v[80:83], v[96:99], v[60:63]
    v_add_u32 v150, s57, v150
    v_add_u32 v151, s57, v151
    v_mfma_f32_16x16x32_bf16 v[36:39], v[76:79], v[96:99], v[36:39]
    v_readlane_b32 s53, v251, s55
    s_add_u32 s55, s55, 1
    v_mfma_f32_16x16x32_bf16 v[12:15], v[72:75], v[96:99], v[12:15]
    s_cmp_eq_u32 s55, 64
    s_cbranch_scc1 P_sw8
    s_waitcnt lgkmcnt(13)
    v_mfma_f32_16x16x32_bf16 v[16:19], v[72:75], v[100:103], v[16:19]
P_swr8:
    s_bfe_i32 s54, s53, 0x9000e
    v_mfma_f32_16x16x32_bf16 v[40:43], v[76:79], v[100:103], v[40:43]
    s_lshl_b32 s54, s54, 10
    s_ashr_i32 s57, s53, 23
    v_mfma_f32_16x16x32_bf16 v[64:67], v[80:83], v[100:103], v[64:67]
    s_lshl_b32 s57, s57, 10
    s_and_b32 s56, s53, 7
    s_waitcnt lgkmcnt(12)
    v_mfma_f32_16x16x32_bf16 v[68:71], v[80:83], v[104:107], v[68:71]
    v_mfma_f32_16x16x32_bf16 v[44:47], v[76:79], v[104:107], v[44:47]
    v_mfma_f32_16x16x32_bf16 v[20:23], v[72:75], v[104:107], v[20:23]
    s_cmp_eq_u32 s56, 1
    s_waitcnt lgkmcnt(0)
    s_cbranch_scc1 P_qq
    s_branch P_disp
P_qtail:
    v_readlane_b32 s53, v251, s55
    s_add_u32 s55, s55, 1
    s_cmp_eq_u32 s55, 64
    s_cbranch_scc1 P_sw9
P_swr9:
    s_bfe_i32 s54, s53, 0x9000e
    s_lshl_b32 s54, s54, 10
    s_ashr_i32 s57, s53, 23
    s_lshl_b32 s57, s57, 10
    s_and_b32 s56, s53, 7
    s_cmp_eq_u32 s56, 1
    s_waitcnt lgkmcnt(0)
    s_cbranch_scc1 P_qq
    s_branch P_disp
P_qw:
    s_barrier
    v_mfma_f32_16x16x32_bf16 v[0:3], v[108:111], v[120:123], v[0:3]
    ds_read_b64_tr_b16 v[72:73], v144 offset:0
    v_mfma_f32_16x16x32_bf16 v[24:27], v[112:115], v[120:123], v[24:27]
    ds_read_b64_tr_b16 v[74:75], v145 offset:0
    v_mfma_f32_16x16x32_bf16 v[48:51], v[116:119], v[120:123], v[48:51]
    ds_read_b128 v[84:87], v150 offset:0
    v_mfma_f32_16x16x32_bf16 v[52:55], v[116:119], v[124:127], v[52:55]
    ds_read_b64_tr_b16 v[76:77], v146 offset:0
    v_mfma_f32_16x16x32_bf16 v[28:31], v[112:115], v[124:127], v[28:31]
    ds_read_b64_tr_b16 v[78:79], v147 offset:0
    v_mfma_f32_16x16x32_bf16 v[4:7], v[108:111], v[124:127], v[4:7]
    ds_read_b64_tr_b16 v[80:81], v148 offset:0
    v_mfma_f32_16x16x32_bf16 v[8:11], v[108:111], v[128:131], v[8:11]
    ds_read_b64_tr_b16 v[82:83], v149 offset:0
    v_mfma_f32_16x16x32_bf16 v[32:35], v[112:115], v[128:131], v[32:35]
    ds_read_b128 v[88:91], v150 offset:2048
    v_mfma_f32_16x16x32_bf16 v[56:59], v[116:119], v[128:131], v[56:59]
    ds_read_b128 v[92:95], v150 offset:4096
    v_mfma_f32_16x16x32_bf16 v[60:63], v[116:119], v[132:135], v[60:63]
    ds_read_b128 v[96:99], v150 offset:6144
    v_mfma_f32_16x16x32_bf16 v[36:39], v[112:115], v[132:135], v[36:39]
    ds_read_b128 v[100:103], v150 offset:8192
    v_mfma_f32_16x16x32_bf16 v[12:15], v[108:111], v[132:135], v[12:15]
    ds_read_b128 v[104:107], v150 offset:10240
    v_mfma_f32_16x16x32_bf16 v[16:19], v[108:111], v[136:139], v[16:19]
    v_mfma_f32_16x16x32_bf16 v[40:43], v[112:115], v[136:139], v[40:43]
    v_mfma_f32_16x16x32_bf16 v[64:67], v[116:119], v[136:139], v[64:67]
    v_mfma_f32_16x16x32_bf16 v[68:71], v[116:119], v[140:143], v[68:71]
    v_mfma_f32_16x16x32_bf16 v[44:47], v[112:115], v[140:143], v[44:47]
    v_mfma_f32_16x16x32_bf16 v[20:23], v[108:111], v[140:143], v[20:23]
    s_waitcnt lgkmcnt(9)
    v_mfma_f32_16x16x32_bf16 v[0:3], v[72:75], v[84:87], v[0:3]
    ds_read_b64_tr_b16 v[108:109], v144 offset:12288
    ds_read_b64_tr_b16 v[110:111], v145 offset:12288
    s_waitcnt lgkmcnt(9)
    v_mfma_f32_16x16x32_bf16 v[24:27], v[76:79], v[84:87], v[24:27]
    ds_read_b64_tr_b16 v[112:113], v146 offset:12288
    ds_read_b64_tr_b16 v[114:115], v147 offset:12288
    s_waitcnt lgkmcnt(9)
    v_mfma_f32_16x16x32_bf16 v[48:51], v[80:83], v[84:87], v[48:51]
    ds_read_b64_tr_b16 v[116:117], v148 offset:12288
    ds_read_b64_tr_b16 v[118:119], v149 offset:12288
    s_waitcnt lgkmcnt(10)
    v_mfma_f32_16x16x32_bf16 v[52:55], v[80:83], v[88:91], v[52:55]
    ds_read_b128 v[120:123], v151 offset:0
    ds_read_b128 v[124:127], v151 offset:2048
    v_mfma_f32_16x16x32_bf16 v[28:31], v[76:79], v[88:91], v[28:31]
    ds_read_b128 v[128:131], v151 offset:4096
    ds_read_b128 v[132:135], v151 offset:6144
    v_mfma_f32_16x16x32_bf16 v[4:7], v[72:75], v[88:91], v[4:7]
    ds_read_b128 v[136:139], v151 offset:8192
    s_waitcnt lgkmcnt(14)
    ds_read_b128 v[140:143], v151 offset:10240
    v_mfma_f32_16x16x32_bf16 v[8:11], v[72:75], v[92:95], v[8:11]
    v_add_u32 v144, s54, v144
    v_add_u32 v145, s54, v145
    v_mfma_f32_16x16x32_bf16 v[32:35], v[76:79], v[92:95], v[32:35]
    v_add_u32 v146, s54, v146
    v_add_u32 v147, s54, v147
    v_mfma_f32_16x16x32_bf16 v[56:59], v[80:83], v[92:95], v[56:59]
    v_add_u32 v148, s54, v148
    v_add_u32 v149, s54, v149
    s_waitcnt lgkmcnt(14)
    v_mfma_f32_16x16x32_bf16 v[60:63], v[80:83], v[96:99], v[60:63]
    v_add_u32 v150, s57, v150
    v_add_u32 v151, s57, v151
    v_mfma_f32_16x16x32_bf16 v[36:39], v[76:79], v[96:99], v[36:39]
    v_mfma_f32_16x16x32_bf16 v[12:15], v[72:75], v[96:99], v[12:15]
    s_waitcnt lgkmcnt(13)
    v_mfma_f32_16x16x32_bf16 v[16:19], v[72:75], v[100:103], v[16:19]
    v_mfma_f32_16x16x32_bf16 v[40:43], v[76:79], v[100:103], v[40:43]
    v_mfma_f32_16x16x32_bf16 v[64:67], v[80:83], v[100:103], v[64:67]
    s_waitcnt lgkmcnt(12)
    v_mfma_f32_16x16x32_bf16 v[68:71], v[80:83], v[104:107], v[68:71]
    v_mfma_f32_16x16x32_bf16 v[44:47], v[76:79], v[104:107], v[44:47]
    v_mfma_f32_16x16x32_bf16 v[20:23], v[72:75], v[104:107], v[20:23]
    s_setprio 0
    ds_write_b64 v250, v[212:213] offset:0
    ds_write_b64 v250, v[214:215] offset:1024
    ds_write_b64 v250, v[216:217] offset:2048
    s_waitcnt lgkmcnt(14)
    ds_write_b64 v250, v[218:219] offset:3072
    s_waitcnt lgkmcnt(14)
    ds_write_b64 v250, v[220:221] offset:4096
    s_waitcnt lgkmcnt(14)
    ds_write_b64 v250, v[222:223] offset:5120
    v_add_u32 v250, s65, v250
    s_waitcnt lgkmcnt(14)
    ds_write_b64 v250, v[224:225] offset:0
    s_waitcnt lgkmcnt(14)
    ds_write_b64 v250, v[226:227] offset:1024
    s_waitcnt lgkmcnt(14)
    ds_write_b64 v250, v[228:229] offset:2048
    s_waitcnt lgkmcnt(14)
    ds_write_b64 v250, v[230:231] offset:3072
    s_waitcnt lgkmcnt(14)
    ds_write_b64 v250, v[232:233] offset:4096
    s_waitcnt lgkmcnt(14)
    ds_write_b64 v250, v[234:235] offset:5120
    v_add_u32 v250, s66, v250
    s_waitcnt lgkmcnt(14)
    ds_write_b64 v250, v[236:237] offset:0
    s_waitcnt lgkmcnt(14)
    ds_write_b64 v250, v[238:239] offset:1024
    s_waitcnt lgkmcnt(14)
    ds_write_b64 v250, v[240:241] offset:2048
    s_waitcnt lgkmcnt(14)
    ds_write_b64 v250, v[242:243] offset:3072
    s_waitcnt lgkmcnt(14)
    ds_write_b64 v250, v[244:245] offset:4096
    s_waitcnt lgkmcnt(14)
    ds_write_b64 v250, v[246:247] offset:5120
    v_add_u32 v250, s67, v250
    s_setprio 1
    s_branch P_qtail
P_qf:
    s_barrier
    v_mfma_f32_16x16x32_bf16 v[0:3], v[108:111], v[120:123], v[0:3]
    ds_read_b64_tr_b16 v[72:73], v144 offset:0
    v_mfma_f32_16x16x32_bf16 v[24:27], v[112:115], v[120:123], v[24:27]
    ds_read_b64_tr_b16 v[74:75], v145 offset:0
    v_mfma_f32_16x16x32_bf16 v[48:51], v[116:119], v[120:123], v[48:51]
    ds_read_b128 v[84:87], v150 offset:0
    v_mfma_f32_16x16x32_bf16 v[52:55], v[116:119], v[124:127], v[52:55]
    ds_read_b64_tr_b16 v[76:77], v146 offset:0
    v_mfma_f32_16x16x32_bf16 v[28:31], v[112:115], v[124:127], v[28:31]
    ds_read_b64_tr_b16 v[78:79], v147 offset:0
    v_mfma_f32_16x16x32_bf16 v[4:7], v[108:111], v[124:127], v[4:7]
    ds_read_b64_tr_b16 v[80:81], v148 offset:0
    v_mfma_f32_16x16x32_bf16 v[8:11], v[108:111], v[128:131], v[8:11]
    ds_read_b64_tr_b16 v[82:83], v149 offset:0
    v_mfma_f32_16x16x32_bf16 v[32:35], v[112:115], v[128:131], v[32:35]
    ds_read_b128 v[88:91], v150 offset:2048
    v_mfma_f32_16x16x32_bf16 v[56:59], v[116:119], v[128:131], v[56:59]
    ds_read_b128 v[92:95], v150 offset:4096
    v_mfma_f32_16x16x32_bf16 v[60:63], v[116:119], v[132:135], v[60:63]
    ds_read_b128 v[96:99], v150 offset:6144
    v_mfma_f32_16x16x32_bf16 v[36:39], v[112:115], v[132:135], v[36:39]
    ds_read_b128 v[100:103], v150 offset:8192
    v_mfma_f32_16x16x32_bf16 v[12:15], v[108:111], v[132:135], v[12:15]
    ds_read_b128 v[104:107], v150 offset:10240
    v_mfma_f32_16x16x32_bf16 v[16:19], v[108:111], v[136:139], v[16:19]
    v_mfma_f32_16x16x32_bf16 v[40:43], v[112:115], v[136:139], v[40:43]
    v_mfma_f32_16x16x32_bf16 v[64:67], v[116:119], v[136:139], v[64:67]
    v_mfma_f32_16x16x32_bf16 v[68:71], v[116:119], v[140:143], v[68:71]
    v_mfma_f32_16x16x32_bf16 v[44:47], v[112:115], v[140:143], v[44:47]
    v_mfma_f32_16x16x32_bf16 v[20:23], v[108:111], v[140:143], v[20:23]
    s_waitcnt lgkmcnt(9)
    v_mfma_f32_16x16x32_bf16 v[0:3], v[72:75], v[84:87], v[0:3]
    ds_read_b64_tr_b16 v[108:109], v144 offset:12288
    ds_read_b64_tr_b16 v[110:111], v145 offset:12288
    s_waitcnt lgkmcnt(9)
    v_mfma_f32_16x16x32_bf16 v[24:27], v[76:79], v[84:87], v[24:27]
    ds_read_b64_tr_b16 v[112:113], v146 offset:12288
    ds_read_b64_tr_b16 v[114:115], v147 offset:12288
    s_waitcnt lgkmcnt(9)
    v_mfma_f32_16x16x32_bf16 v[48:51], v[80:83], v[84:87], v[48:51]
    ds_read_b64_tr_b16 v[116:117], v148 offset:12288
    ds_read_b64_tr_b16 v[118:119], v149 offset:12288
    s_waitcnt lgkmcnt(10)
    v_mfma_f32_16x16x32_bf16 v[52:55], v[80:83], v[88:91], v[52:55]
    ds_read_b128 v[120:123], v151 offset:0
    ds_read_b128 v[124:127], v151 offset:2048
    v_mfma_f32_16x16x32_bf16 v[28:31], v[76:79], v[88:91], v[28:31]
    ds_read_b128 v[128:131], v151 offset:4096
    ds_read_b128 v[132:135], v151 offset:6144
    v_mfma_f32_16x16x32_bf16 v[4:7], v[72:75], v[88:91], v[4:7]
    ds_read_b128 v[136:139], v151 offset:8192
    s_waitcnt lgkmcnt(14)
    ds_read_b128 v[140:143], v151 offset:10240
    v_mfma_f32_16x16x32_bf16 v[8:11], v[72:75], v[92:95], v[8:11]
    v_add_u32 v144, s54, v144
    v_add_u32 v145, s54, v145
    v_mfma_f32_16x16x32_bf16 v[32:35], v[76:79], v[92:95], v[32:35]
    v_add_u32 v146, s54, v146
    v_add_u32 v147, s54, v147
    v_mfma_f32_16x16x32_bf16 v[56:59], v[80:83], v[92:95], v[56:59]
    v_add_u32 v148, s54, v148
    v_add_u32 v149, s54, v149
    s_waitcnt lgkmcnt(14)
    v_mfma_f32_16x16x32_bf16 v[60:63], v[80:83], v[96:99], v[60:63]
    v_add_u32 v150, s57, v150
    v_add_u32 v151, s57, v151
    v_mfma_f32_16x16x32_bf16 v[36:39], v[76:79], v[96:99], v[36:39]
    v_mfma_f32_16x16x32_bf16 v[12:15], v[72:75], v[96:99], v[12:15]
    s_waitcnt lgkmcnt(13)
    v_mfma_f32_16x16x32_bf16 v[16:19], v[72:75], v[100:103], v[16:19]
    v_mfma_f32_16x16x32_bf16 v[40:43], v[76:79], v[100:103], v[40:43]
    v_mfma_f32_16x16x32_bf16 v[64:67], v[80:83], v[100:103], v[64:67]
    s_waitcnt lgkmcnt(12)
    v_mfma_f32_16x16x32_bf16 v[68:71], v[80:83], v[104:107], v[68:71]
    v_mfma_f32_16x16x32_bf16 v[44:47], v[76:79], v[104:107], v[44:47]
    v_mfma_f32_16x16x32_bf16 v[20:23], v[72:75], v[104:107], v[20:23]
    s_waitcnt lgkmcnt(5)
    v_mfma_f32_16x16x32_bf16 v[0:3], v[108:111], v[120:123], v[0:3]
    s_waitcnt lgkmcnt(4)
    v_mfma_f32_16x16x32_bf16 v[4:7], v[108:111], v[124:127], v[4:7]
    s_waitcnt lgkmcnt(3)
    v_mfma_f32_16x16x32_bf16 v[8:11], v[108:111], v[128:131], v[8:11]
    s_waitcnt lgkmcnt(2)
    v_mfma_f32_16x16x32_bf16 v[12:15], v[108:111], v[132:135], v[12:15]
    s_waitcnt lgkmcnt(1)
    v_mfma_f32_16x16x32_bf16 v[16:19], v[108:111], v[136:139], v[16:19]
    v_pk_mul_f32 v[0:1], v[0:1], s[62:63]
    v_pk_mul_f32 v[2:3], v[2:3], s[62:63]
    v_cvt_pk_bf16_f32 v212, v0, v1
    v_cvt_pk_bf16_f32 v213, v2, v3
    ds_write_b64 v250, v[212:213] offset:0
    s_waitcnt lgkmcnt(1)
    v_mfma_f32_16x16x32_bf16 v[20:23], v[108:111], v[140:143], v[20:23]
    v_pk_mul_f32 v[4:5], v[4:5], s[62:63]
    v_pk_mul_f32 v[6:7], v[6:7], s[62:63]
    v_cvt_pk_bf16_f32 v214, v4, v5
    v_cvt_pk_bf16_f32 v215, v6, v7
    ds_write_b64 v250, v[214:215] offset:1024
    v_mfma_f32_16x16x32_bf16 v[24:27], v[112:115], v[120:123], v[24:27]
    v_pk_mul_f32 v[8:9], v[8:9], s[62:63]
    v_pk_mul_f32 v[10:11], v[10:11], s[62:63]
    v_cvt_pk_bf16_f32 v216, v8, v9
    v_cvt_pk_bf16_f32 v217, v10, v11
    ds_write_b64 v250, v[216:217] offset:2048
    v_mfma_f32_16x16x32_bf16 v[28:31], v[112:115], v[124:127], v[28:31]
    v_pk_mul_f32 v[12:13], v[12:13], s[62:63]
    v_pk_mul_f32 v[14:15], v[14:15], s[62:63]
    v_cvt_pk_bf16_f32 v218, v12, v13
    v_cvt_pk_bf16_f32 v219, v14, v15
    ds_write_b64 v250, v[218:219] offset:3072
    v_mfma_f32_16x16x32_bf16 v[32:35], v[112:115], v[128:131], v[32:35]
    v_pk_mul_f32 v[16:17], v[16:17], s[62:63]
    v_pk_mul_f32 v[18:19], v[18:19], s[62:63]
    v_cvt_pk_bf16_f32 v220, v16, v17
    v_cvt_pk_bf16_f32 v221, v18, v19
    ds_write_b64 v250, v[220:221] offset:4096
    v_mfma_f32_16x16x32_bf16 v[36:39], v[112:115], v[132:135], v[36:39]
    v_pk_mul_f32 v[20:21], v[20:21], s[62:63]
    v_pk_mul_f32 v[22:23], v[22:23], s[62:63]
    v_cvt_pk_bf16_f32 v222, v20, v21
    v_cvt_pk_bf16_f32 v223, v22, v23
    ds_write_b64 v250, v[222:223] offset:5120
    v_add_u32 v250, s65, v250
    v_mfma_f32_16x16x32_bf16 v[40:43], v[112:115], v[136:139], v[40:43]
    v_pk_mul_f32 v[24:25], v[24:25], s[62:63]
    v_pk_mul_f32 v[26:27], v[26:27], s[62:63]
    v_cvt_pk_bf16_f32 v224, v24, v25
    v_cvt_pk_bf16_f32 v225, v26, v27
    ds_write_b64 v250, v[224:225] offset:0
    v_mfma_f32_16x16x32_bf16 v[44:47], v[112:115], v[140:143], v[44:47]
    v_pk_mul_f32 v[28:29], v[28:29], s[62:63]
    v_pk_mul_f32 v[30:31], v[30:31], s[62:63]
    v_cvt_pk_bf16_f32 v226, v28, v29
    v_cvt_pk_bf16_f32 v227, v30, v31
    ds_write_b64 v250, v[226:227] offset:1024
    v_mfma_f32_16x16x32_bf16 v[48:51], v[116:119], v[120:123], v[48:51]
    v_pk_mul_f32 v[32:33], v[32:33], s[62:63]
    v_pk_mul_f32 v[34:35], v[34:35], s[62:63]
    v_cvt_pk_bf16_f32 v228, v32, v33
    v_cvt_pk_bf16_f32 v229, v34, v35
    ds_write_b64 v250, v[228:229] offset:2048
    v_mfma_f32_16x16x32_bf16 v[52:55], v[116:119], v[124:127], v[52:55]
    v_pk_mul_f32 v[36:37], v[36:37], s[62:63]
    v_pk_mul_f32 v[38:39], v[38:39], s[62:63]
    v_cvt_pk_bf16_f32 v230, v36, v37
    v_cvt_pk_bf16_f32 v231, v38, v39
    ds_write_b64 v250, v[230:231] offset:3072
    v_mfma_f32_16x16x32_bf16 v[56:59], v[116:119], v[128:131], v[56:59]
    v_pk_mul_f32 v[40:41], v[40:41], s[62:63]
    v_pk_mul_f32 v[42:43], v[42:43], s[62:63]
    v_cvt_pk_bf16_f32 v232, v40, v41
    v_cvt_pk_bf16_f32 v233, v42, v43
    ds_write_b64 v250, v[232:233] offset:4096
    v_mfma_f32_16x16x32_bf16 v[60:63], v[116:119], v[132:135], v[60:63]
    v_pk_mul_f32 v[44:45], v[44:45], s[62:63]
    v_pk_mul_f32 v[46:47], v[46:47], s[62:63]
    v_cvt_pk_bf16_f32 v234, v44, v45
    v_cvt_pk_bf16_f32 v235, v46, v47
    ds_write_b64 v250, v[234:235] offset:5120
    v_add_u32 v250, s66, v250
    v_mfma_f32_16x16x32_bf16 v[64:67], v[116:119], v[136:139], v[64:67]
    v_pk_mul_f32 v[48:49], v[48:49], s[62:63]
    v_pk_mul_f32 v[50:51], v[50:51], s[62:63]
    v_cvt_pk_bf16_f32 v236, v48, v49
    v_cvt_pk_bf16_f32 v237, v50, v51
    ds_write_b64 v250, v[236:237] offset:0
    v_mfma_f32_16x16x32_bf16 v[68:71], v[116:119], v[140:143], v[68:71]
    v_pk_mul_f32 v[52:53], v[52:53], s[62:63]
    v_pk_mul_f32 v[54:55], v[54:55], s[62:63]
    v_cvt_pk_bf16_f32 v238, v52, v53
    v_cvt_pk_bf16_f32 v239, v54, v55
    ds_write_b64 v250, v[238:239] offset:1024
    v_pk_mul_f32 v[56:57], v[56:57], s[62:63]
    v_pk_mul_f32 v[58:59], v[58:59], s[62:63]
    v_cvt_pk_bf16_f32 v240, v56, v57
    v_cvt_pk_bf16_f32 v241, v58, v59
    ds_write_b64 v250, v[240:241] offset:2048
    v_pk_mul_f32 v[60:61], v[60:61], s[62:63]
    v_pk_mul_f32 v[62:63], v[62:63], s[62:63]
    v_cvt_pk_bf16_f32 v242, v60, v61
    v_cvt_pk_bf16_f32 v243, v62, v63
    s_waitcnt lgkmcnt(14)
    ds_write_b64 v250, v[242:243] offset:3072
    v_pk_mul_f32 v[64:65], v[64:65], s[62:63]
    v_pk_mul_f32 v[66:67], v[66:67], s[62:63]
    v_cvt_pk_bf16_f32 v244, v64, v65
    v_cvt_pk_bf16_f32 v245, v66, v67
    s_waitcnt lgkmcnt(14)
    ds_write_b64 v250, v[244:245] offset:4096
    v_pk_mul_f32 v[68:69], v[68:69], s[62:63]
    v_pk_mul_f32 v[70:71], v[70:71], s[62:63]
    v_cvt_pk_bf16_f32 v246, v68, v69
    v_cvt_pk_bf16_f32 v247, v70, v71
    s_waitcnt lgkmcnt(14)
    ds_write_b64 v250, v[246:247] offset:5120
    v_add_u32 v250, s67, v250
    s_branch P_qtail
P_oo:
    s_barrier
P_oo2:
    v_mfma_f32_16x16x32_bf16 v[0:3], v[180:183], v[200:203], v[0:3]
    v_mfma_f32_16x16x32_bf16 v[4:7], v[184:187], v[200:203], v[4:7]
    v_mfma_f32_16x16x32_bf16 v[8:11], v[188:191], v[200:203], v[8:11]
    v_mfma_f32_16x16x32_bf16 v[12:15], v[192:195], v[200:203], v[12:15]
    v_mfma_f32_16x16x32_bf16 v[16:19], v[196:199], v[200:203], v[16:19]
    ds_read_b128 v[200:203], v248 offset:3072
    v_mfma_f32_16x16x32_bf16 v[36:39], v[196:199], v[204:207], v[36:39]
    v_mfma_f32_16x16x32_bf16 v[32:35], v[192:195], v[204:207], v[32:35]
    v_mfma_f32_16x16x32_bf16 v[28:31], v[188:191], v[204:207], v[28:31]
    v_mfma_f32_16x16x32_bf16 v[24:27], v[184:187], v[204:207], v[24:27]
    v_mfma_f32_16x16x32_bf16 v[20:23], v[180:183], v[204:207], v[20:23]
    ds_read_b128 v[204:207], v248 offset:4096
    v_mfma_f32_16x16x32_bf16 v[40:43], v[180:183], v[208:211], v[40:43]
    v_mfma_f32_16x16x32_bf16 v[44:47], v[184:187], v[208:211], v[44:47]
    v_mfma_f32_16x16x32_bf16 v[48:51], v[188:191], v[208:211], v[48:51]
    v_mfma_f32_16x16x32_bf16 v[52:55], v[192:195], v[208:211], v[52:55]
    v_mfma_f32_16x16x32_bf16 v[56:59], v[196:199], v[208:211], v[56:59]
    ds_read_b128 v[208:211], v248 offset:5120
    v_add_u32 v248, s57, v248
    s_waitcnt lgkmcnt(2)
    v_mfma_f32_16x16x32_bf16 v[76:79], v[196:199], v[200:203], v[76:79]
    v_mfma_f32_16x16x32_bf16 v[72:75], v[192:195], v[200:203], v[72:75]
    v_mfma_f32_16x16x32_bf16 v[68:71], v[188:191], v[200:203], v[68:71]
    v_mfma_f32_16x16x32_bf16 v[64:67], v[184:187], v[200:203], v[64:67]
    v_mfma_f32_16x16x32_bf16 v[60:63], v[180:183], v[200:203], v[60:63]
    ds_read_b128 v[200:203], v248 offset:0
    s_waitcnt lgkmcnt(2)
    v_mfma_f32_16x16x32_bf16 v[80:83], v[180:183], v[204:207], v[80:83]
    v_mfma_f32_16x16x32_bf16 v[84:87], v[184:187], v[204:207], v[84:87]
    v_mfma_f32_16x16x32_bf16 v[88:91], v[188:191], v[204:207], v[88:91]
    v_mfma_f32_16x16x32_bf16 v[92:95], v[192:195], v[204:207], v[92:95]
    v_mfma_f32_16x16x32_bf16 v[96:99], v[196:199], v[204:207], v[96:99]
    ds_read_b128 v[204:207], v248 offset:1024
    s_waitcnt lgkmcnt(2)
    v_mfma_f32_16x16x32_bf16 v[116:119], v[196:199], v[208:211], v[116:119]
    ds_read_b64_tr_b16 v[196:197], v249 offset:128
    ds_read_b64_tr_b16 v[198:199], v249 offset:2688
    v_mfma_f32_16x16x32_bf16 v[112:115], v[192:195], v[208:211], v[112:115]
    ds_read_b64_tr_b16 v[192:193], v249 offset:96
    ds_read_b64_tr_b16 v[194:195], v249 offset:2656
    v_mfma_f32_16x16x32_bf16 v[108:111], v[188:191], v[208:211], v[108:111]
    ds_read_b64_tr_b16 v[188:189], v249 offset:64
    ds_read_b64_tr_b16 v[190:191], v249 offset:2624
    v_mfma_f32_16x16x32_bf16 v[104:107], v[184:187], v[208:211], v[104:107]
    ds_read_b64_tr_b16 v[184:185], v249 offset:32
    ds_read_b64_tr_b16 v[186:187], v249 offset:2592
    v_mfma_f32_16x16x32_bf16 v[100:103], v[180:183], v[208:211], v[100:103]
    ds_read_b64_tr_b16 v[180:181], v249 offset:0
    ds_read_b64_tr_b16 v[182:183], v249 offset:2560
    ds_read_b128 v[208:211], v248 offset:2048
    v_add_u32 v249, s54, v249
    s_bitcmp1_b32 s53, 12
    s_cbranch_scc1 P_swap
P_swapr:
    s_setprio 1
    v_readlane_b32 s53, v251, s55
    s_add_u32 s55, s55, 1
    s_cmp_eq_u32 s55, 64
    s_cbranch_scc1 P_sw10
P_swr10:
    s_bfe_i32 s54, s53, 0x9000e
    s_lshl_b32 s54, s54, 10
    s_ashr_i32 s57, s53, 23
    s_lshl_b32 s57, s57, 10
    s_and_b32 s56, s53, 7
    s_cmp_eq_u32 s56, 2
    s_waitcnt lgkmcnt(0)
    s_cbranch_scc1 P_oo
    s_branch P_disp
P_gen:
    s_barrier
    s_bitcmp1_b32 s53, 6
    s_cbranch_scc0 P_gq
    s_bitcmp1_b32 s53, 11
    s_cbranch_scc0 P_gn
    ds_read_b128 v[200:203], v248 offset:0
    ds_read_b128 v[204:207], v248 offset:1024
    ds_read_b128 v[208:211], v248 offset:2048
    s_waitcnt lgkmcnt(0)
P_gn:
    s_bitcmp1_b32 s53, 8
    s_cbranch_scc0 P_oo2
    v_mfma_f32_16x16x32_bf16 v[0:3], v[180:183], v[200:203], v[0:3]
    v_mfma_f32_16x16x32_bf16 v[4:7], v[184:187], v[200:203], v[4:7]
    v_mfma_f32_16x16x32_bf16 v[8:11], v[188:191], v[200:203], v[8:11]
    v_mfma_f32_16x16x32_bf16 v[12:15], v[192:195], v[200:203], v[12:15]
    v_mfma_f32_16x16x32_bf16 v[16:19], v[196:199], v[200:203], v[16:19]
    ds_read_b128 v[200:203], v248 offset:3072
    v_mfma_f32_16x16x32_bf16 v[36:39], v[196:199], v[204:207], v[36:39]
    v_mfma_f32_16x16x32_bf16 v[32:35], v[192:195], v[204:207], v[32:35]
    v_mfma_f32_16x16x32_bf16 v[28:31], v[188:191], v[204:207], v[28:31]
    v_mfma_f32_16x16x32_bf16 v[24:27], v[184:187], v[204:207], v[24:27]
    v_mfma_f32_16x16x32_bf16 v[20:23], v[180:183], v[204:207], v[20:23]
    ds_read_b128 v[204:207], v248 offset:4096
    v_mfma_f32_16x16x32_bf16 v[40:43], v[180:183], v[208:211], v[40:43]
    v_mfma_f32_16x16x32_bf16 v[44:47], v[184:187], v[208:211], v[44:47]
    v_mfma_f32_16x16x32_bf16 v[48:51], v[188:191], v[208:211], v[48:51]
    v_mfma_f32_16x16x32_bf16 v[52:55], v[192:195], v[208:211], v[52:55]
    v_mfma_f32_16x16x32_bf16 v[56:59], v[196:199], v[208:211], v[56:59]
    ds_read_b128 v[208:211], v248 offset:5120
    v_add_u32 v248, s57, v248
    s_waitcnt lgkmcnt(2)
    v_mfma_f32_16x16x32_bf16 v[76:79], v[196:199], v[200:203], v[76:79]
    v_mfma_f32_16x16x32_bf16 v[72:75], v[192:195], v[200:203], v[72:75]
    v_mfma_f32_16x16x32_bf16 v[68:71], v[188:191], v[200:203], v[68:71]
    v_mfma_f32_16x16x32_bf16 v[64:67], v[184:187], v[200:203], v[64:67]
    v_mfma_f32_16x16x32_bf16 v[60:63], v[180:183], v[200:203], v[60:63]
    ds_read_b128 v[200:203], v248 offset:0
    s_waitcnt lgkmcnt(2)
    v_mfma_f32_16x16x32_bf16 v[80:83], v[180:183], v[204:207], v[80:83]
    v_mfma_f32_16x16x32_bf16 v[84:87], v[184:187], v[204:207], v[84:87]
    v_mfma_f32_16x16x32_bf16 v[88:91], v[188:191], v[204:207], v[88:91]
    v_mfma_f32_16x16x32_bf16 v[92:95], v[192:195], v[204:207], v[92:95]
    v_mfma_f32_16x16x32_bf16 v[96:99], v[196:199], v[204:207], v[96:99]
    ds_read_b128 v[204:207], v248 offset:1024
    s_waitcnt lgkmcnt(2)
    v_mfma_f32_16x16x32_bf16 v[116:119], v[196:199], v[208:211], v[116:119]
    ds_read_b64_tr_b16 v[196:197], v249 offset:128
    ds_read_b64_tr_b16 v[198:199], v249 offset:2688
    v_mfma_f32_16x16x32_bf16 v[112:115], v[192:195], v[208:211], v[112:115]
    ds_read_b64_tr_b16 v[192:193], v249 offset:96
    ds_read_b64_tr_b16 v[194:195], v249 offset:2656
    v_mfma_f32_16x16x32_bf16 v[108:111], v[188:191], v[208:211], v[108:111]
    ds_read_b64_tr_b16 v[188:189], v249 offset:64
    ds_read_b64_tr_b16 v[190:191], v249 offset:2624
    v_mfma_f32_16x16x32_bf16 v[104:107], v[184:187], v[208:211], v[104:107]
    ds_read_b64_tr_b16 v[184:185], v249 offset:32
    ds_read_b64_tr_b16 v[186:187], v249 offset:2592
    v_mfma_f32_16x16x32_bf16 v[100:103], v[180:183], v[208:211], v[100:103]
    ds_read_b64_tr_b16 v[180:181], v249 offset:0
    ds_read_b64_tr_b16 v[182:183], v249 offset:2560
    ds_read_b128 v[208:211], v248 offset:2048
    s_setprio 0
    ds_write_b64 v250, v[212:213] offset:0
    ds_write_b64 v250, v[214:215] offset:1024
    s_waitcnt lgkmcnt(14)
    ds_write_b64 v250, v[216:217] offset:2048
    s_waitcnt lgkmcnt(14)
    ds_write_b64 v250, v[218:219] offset:3072
    s_waitcnt lgkmcnt(14)
    ds_write_b64 v250, v[220:221] offset:4096
    s_waitcnt lgkmcnt(14)
    ds_write_b64 v250, v[222:223] offset:5120
    v_add_u32 v250, s65, v250
    s_waitcnt lgkmcnt(14)
    ds_write_b64 v250, v[224:225] offset:0
    s_waitcnt lgkmcnt(14)
    ds_write_b64 v250, v[226:227] offset:1024
    s_waitcnt lgkmcnt(14)
    ds_write_b64 v250, v[228:229] offset:2048
    s_waitcnt lgkmcnt(14)
    ds_write_b64 v250, v[230:231] offset:3072
    s_waitcnt lgkmcnt(14)
    ds_write_b64 v250, v[232:233] offset:4096
    s_waitcnt lgkmcnt(14)
    ds_write_b64 v250, v[234:235] offset:5120
    v_add_u32 v250, s66, v250
    s_waitcnt lgkmcnt(14)
    ds_write_b64 v250, v[236:237] offset:0
    s_waitcnt lgkmcnt(14)
    ds_write_b64 v250, v[238:239] offset:1024
    s_waitcnt lgkmcnt(14)
    ds_write_b64 v250, v[240:241] offset:2048
    s_waitcnt lgkmcnt(14)
    ds_write_b64 v250, v[242:243] offset:3072
    s_waitcnt lgkmcnt(14)
    ds_write_b64 v250, v[244:245] offset:4096
    s_waitcnt lgkmcnt(14)
    ds_write_b64 v250, v[246:247] offset:5120
    v_add_u32 v250, s67, v250
    s_setprio 1
    v_add_u32 v249, s54, v249
    s_branch P_next
P_gq:
    s_bitcmp1_b32 s53, 3
    s_cbranch_scc0 P_g0
    ds_read_b64_tr_b16 v[72:73], v144 offset:0
    ds_read_b64_tr_b16 v[74:75], v145 offset:0
    ds_read_b64_tr_b16 v[76:77], v146 offset:0
    ds_read_b64_tr_b16 v[78:79], v147 offset:0
    ds_read_b64_tr_b16 v[80:81], v148 offset:0
    ds_read_b64_tr_b16 v[82:83], v149 offset:0
    ds_read_b128 v[84:87], v150 offset:0
    ds_read_b128 v[88:91], v150 offset:2048
    ds_read_b128 v[92:95], v150 offset:4096
    ds_read_b128 v[96:99], v150 offset:6144
    ds_read_b128 v[100:103], v150 offset:8192
    ds_read_b128 v[104:107], v150 offset:10240
P_g0:
    s_bitcmp1_b32 s53, 5
    s_cbranch_scc0 P_g2
    v_mfma_f32_16x16x32_bf16 v[0:3], v[108:111], v[120:123], v[0:3]
    v_mfma_f32_16x16x32_bf16 v[24:27], v[112:115], v[120:123], v[24:27]
    v_mfma_f32_16x16x32_bf16 v[48:51], v[116:119], v[120:123], v[48:51]
    v_mfma_f32_16x16x32_bf16 v[52:55], v[116:119], v[124:127], v[52:55]
    v_mfma_f32_16x16x32_bf16 v[28:31], v[112:115], v[124:127], v[28:31]
    v_mfma_f32_16x16x32_bf16 v[4:7], v[108:111], v[124:127], v[4:7]
    v_mfma_f32_16x16x32_bf16 v[8:11], v[108:111], v[128:131], v[8:11]
    v_mfma_f32_16x16x32_bf16 v[32:35], v[112:115], v[128:131], v[32:35]
    v_mfma_f32_16x16x32_bf16 v[56:59], v[116:119], v[128:131], v[56:59]
    v_mfma_f32_16x16x32_bf16 v[60:63], v[116:119], v[132:135], v[60:63]
    v_mfma_f32_16x16x32_bf16 v[36:39], v[112:115], v[132:135], v[36:39]
    v_mfma_f32_16x16x32_bf16 v[12:15], v[108:111], v[132:135], v[12:15]
    v_mfma_f32_16x16x32_bf16 v[16:19], v[108:111], v[136:139], v[16:19]
    v_mfma_f32_16x16x32_bf16 v[40:43], v[112:115], v[136:139], v[40:43]
    v_mfma_f32_16x16x32_bf16 v[64:67], v[116:119], v[136:139], v[64:67]
    v_mfma_f32_16x16x32_bf16 v[68:71], v[116:119], v[140:143], v[68:71]
    v_mfma_f32_16x16x32_bf16 v[44:47], v[112:115], v[140:143], v[44:47]
    v_mfma_f32_16x16x32_bf16 v[20:23], v[108:111], v[140:143], v[20:23]
P_g2:
    s_bitcmp1_b32 s53, 7
    s_cbranch_scc0 P_np
    v_pk_mul_f32 v[0:1], v[0:1], s[62:63]
    v_pk_mul_f32 v[2:3], v[2:3], s[62:63]
    v_cvt_pk_bf16_f32 v212, v0, v1
    v_cvt_pk_bf16_f32 v213, v2, v3
    v_pk_mul_f32 v[4:5], v[4:5], s[62:63]
    v_pk_mul_f32 v[6:7], v[6:7], s[62:63]
    v_cvt_pk_bf16_f32 v214, v4, v5
    v_cvt_pk_bf16_f32 v215, v6, v7
    v_pk_mul_f32 v[8:9], v[8:9], s[62:63]
    v_pk_mul_f32 v[10:11], v[10:11], s[62:63]
    v_cvt_pk_bf16_f32 v216, v8, v9
    v_cvt_pk_bf16_f32 v217, v10, v11
    v_pk_mul_f32 v[12:13], v[12:13], s[62:63]
    v_pk_mul_f32 v[14:15], v[14:15], s[62:63]
    v_cvt_pk_bf16_f32 v218, v12, v13
    v_cvt_pk_bf16_f32 v219, v14, v15
    v_pk_mul_f32 v[16:17], v[16:17], s[62:63]
    v_pk_mul_f32 v[18:19], v[18:19], s[62:63]
    v_cvt_pk_bf16_f32 v220, v16, v17
    v_cvt_pk_bf16_f32 v221, v18, v19
    v_pk_mul_f32 v[20:21], v[20:21], s[62:63]
    v_pk_mul_f32 v[22:23], v[22:23], s[62:63]
    v_cvt_pk_bf16_f32 v222, v20, v21
    v_cvt_pk_bf16_f32 v223, v22, v23
    v_pk_mul_f32 v[24:25], v[24:25], s[62:63]
    v_pk_mul_f32 v[26:27], v[26:27], s[62:63]
    v_cvt_pk_bf16_f32 v224, v24, v25
    v_cvt_pk_bf16_f32 v225, v26, v27
    v_pk_mul_f32 v[28:29], v[28:29], s[62:63]
    v_pk_mul_f32 v[30:31], v[30:31], s[62:63]
    v_cvt_pk_bf16_f32 v226, v28, v29
    v_cvt_pk_bf16_f32 v227, v30, v31
    v_pk_mul_f32 v[32:33], v[32:33], s[62:63]
    v_pk_mul_f32 v[34:35], v[34:35], s[62:63]
    v_cvt_pk_bf16_f32 v228, v32, v33
    v_cvt_pk_bf16_f32 v229, v34, v35
    v_pk_mul_f32 v[36:37], v[36:37], s[62:63]
    v_pk_mul_f32 v[38:39], v[38:39], s[62:63]
    v_cvt_pk_bf16_f32 v230, v36, v37
    v_cvt_pk_bf16_f32 v231, v38, v39
    v_pk_mul_f32 v[40:41], v[40:41], s[62:63]
    v_pk_mul_f32 v[42:43], v[42:43], s[62:63]
    v_cvt_pk_bf16_f32 v232, v40, v41
    v_cvt_pk_bf16_f32 v233, v42, v43
    v_pk_mul_f32 v[44:45], v[44:45], s[62:63]
    v_pk_mul_f32 v[46:47], v[46:47], s[62:63]
    v_cvt_pk_bf16_f32 v234, v44, v45
    v_cvt_pk_bf16_f32 v235, v46, v47
    v_pk_mul_f32 v[48:49], v[48:49], s[62:63]
    v_pk_mul_f32 v[50:51], v[50:51], s[62:63]
    v_cvt_pk_bf16_f32 v236, v48, v49
    v_cvt_pk_bf16_f32 v237, v50, v51
    v_pk_mul_f32 v[52:53], v[52:53], s[62:63]
    v_pk_mul_f32 v[54:55], v[54:55], s[62:63]
    v_cvt_pk_bf16_f32 v238, v52, v53
    v_cvt_pk_bf16_f32 v239, v54, v55
    v_pk_mul_f32 v[56:57], v[56:57], s[62:63]
    v_pk_mul_f32 v[58:59], v[58:59], s[62:63]
    v_cvt_pk_bf16_f32 v240, v56, v57
    v_cvt_pk_bf16_f32 v241, v58, v59
    v_pk_mul_f32 v[60:61], v[60:61], s[62:63]
    v_pk_mul_f32 v[62:63], v[62:63], s[62:63]
    v_cvt_pk_bf16_f32 v242, v60, v61
    v_cvt_pk_bf16_f32 v243, v62, v63
    v_pk_mul_f32 v[64:65], v[64:65], s[62:63]
    v_pk_mul_f32 v[66:67], v[66:67], s[62:63]
    v_cvt_pk_bf16_f32 v244, v64, v65
    v_cvt_pk_bf16_f32 v245, v66, v67
    v_pk_mul_f32 v[68:69], v[68:69], s[62:63]
    v_pk_mul_f32 v[70:71], v[70:71], s[62:63]
    v_cvt_pk_bf16_f32 v246, v68, v69
    v_cvt_pk_bf16_f32 v247, v70, v71
P_np:
    s_waitcnt lgkmcnt(0)
    s_bitcmp1_b32 s53, 3
    s_cbranch_scc0 P_g3
    ds_read_b64_tr_b16 v[108:109], v144 offset:12288
    ds_read_b64_tr_b16 v[110:111], v145 offset:12288
    ds_read_b64_tr_b16 v[112:113], v146 offset:12288
    ds_read_b64_tr_b16 v[114:115], v147 offset:12288
    ds_read_b64_tr_b16 v[116:117], v148 offset:12288
    ds_read_b64_tr_b16 v[118:119], v149 offset:12288
    ds_read_b128 v[120:123], v151 offset:0
    ds_read_b128 v[124:127], v151 offset:2048
    ds_read_b128 v[128:131], v151 offset:4096
    ds_read_b128 v[132:135], v151 offset:6144
    ds_read_b128 v[136:139], v151 offset:8192
    ds_read_b128 v[140:143], v151 offset:10240
    s_bitcmp1_b32 s53, 9
    s_cbranch_scc1 P_gz
    v_mfma_f32_16x16x32_bf16 v[0:3], v[72:75], v[84:87], v[0:3]
    v_mfma_f32_16x16x32_bf16 v[24:27], v[76:79], v[84:87], v[24:27]
    v_mfma_f32_16x16x32_bf16 v[48:51], v[80:83], v[84:87], v[48:51]
    v_mfma_f32_16x16x32_bf16 v[52:55], v[80:83], v[88:91], v[52:55]
    v_mfma_f32_16x16x32_bf16 v[28:31], v[76:79], v[88:91], v[28:31]
    v_mfma_f32_16x16x32_bf16 v[4:7], v[72:75], v[88:91], v[4:7]
    v_mfma_f32_16x16x32_bf16 v[8:11], v[72:75], v[92:95], v[8:11]
    v_mfma_f32_16x16x32_bf16 v[32:35], v[76:79], v[92:95], v[32:35]
    v_mfma_f32_16x16x32_bf16 v[56:59], v[80:83], v[92:95], v[56:59]
    v_mfma_f32_16x16x32_bf16 v[60:63], v[80:83], v[96:99], v[60:63]
    v_mfma_f32_16x16x32_bf16 v[36:39], v[76:79], v[96:99], v[36:39]
    v_mfma_f32_16x16x32_bf16 v[12:15], v[72:75], v[96:99], v[12:15]
    v_mfma_f32_16x16x32_bf16 v[16:19], v[72:75], v[100:103], v[16:19]
    v_mfma_f32_16x16x32_bf16 v[40:43], v[76:79], v[100:103], v[40:43]
    v_mfma_f32_16x16x32_bf16 v[64:67], v[80:83], v[100:103], v[64:67]
    v_mfma_f32_16x16x32_bf16 v[68:71], v[80:83], v[104:107], v[68:71]
    v_mfma_f32_16x16x32_bf16 v[44:47], v[76:79], v[104:107], v[44:47]
    v_mfma_f32_16x16x32_bf16 v[20:23], v[72:75], v[104:107], v[20:23]
    s_branch P_g3
P_gz:
    v_mfma_f32_16x16x32_bf16 v[0:3], v[72:75], v[84:87], 0
    v_mfma_f32_16x16x32_bf16 v[24:27], v[76:79], v[84:87], 0
    v_mfma_f32_16x16x32_bf16 v[48:51], v[80:83], v[84:87], 0
    v_mfma_f32_16x16x32_bf16 v[52:55], v[80:83], v[88:91], 0
    v_mfma_f32_16x16x32_bf16 v[28:31], v[76:79], v[88:91], 0
    v_mfma_f32_16x16x32_bf16 v[4:7], v[72:75], v[88:91], 0
    v_mfma_f32_16x16x32_bf16 v[8:11], v[72:75], v[92:95], 0
    v_mfma_f32_16x16x32_bf16 v[32:35], v[76:79], v[92:95], 0
    v_mfma_f32_16x16x32_bf16 v[56:59], v[80:83], v[92:95], 0
    v_mfma_f32_16x16x32_bf16 v[60:63], v[80:83], v[96:99], 0
    v_mfma_f32_16x16x32_bf16 v[36:39], v[76:79], v[96:99], 0
    v_mfma_f32_16x16x32_bf16 v[12:15], v[72:75], v[96:99], 0
    v_mfma_f32_16x16x32_bf16 v[16:19], v[72:75], v[100:103], 0
    v_mfma_f32_16x16x32_bf16 v[40:43], v[76:79], v[100:103], 0
    v_mfma_f32_16x16x32_bf16 v[64:67], v[80:83], v[100:103], 0
    v_mfma_f32_16x16x32_bf16 v[68:71], v[80:83], v[104:107], 0
    v_mfma_f32_16x16x32_bf16 v[44:47], v[76:79], v[104:107], 0
    v_mfma_f32_16x16x32_bf16 v[20:23], v[72:75], v[104:107], 0
P_g3:
    s_bitcmp1_b32 s53, 4
    s_cbranch_scc0 P_g4
    ds_read_b64_tr_b16 v[180:181], v249 offset:0
    ds_read_b64_tr_b16 v[182:183], v249 offset:2560
    ds_read_b64_tr_b16 v[184:185], v249 offset:32
    ds_read_b64_tr_b16 v[186:187], v249 offset:2592
    ds_read_b64_tr_b16 v[188:189], v249 offset:64
    ds_read_b64_tr_b16 v[190:191], v249 offset:2624
    ds_read_b64_tr_b16 v[192:193], v249 offset:96
    ds_read_b64_tr_b16 v[194:195], v249 offset:2656
    ds_read_b64_tr_b16 v[196:197], v249 offset:128
    ds_read_b64_tr_b16 v[198:199], v249 offset:2688
    ds_read_b128 v[200:203], v248 offset:0
    ds_read_b128 v[204:207], v248 offset:1024
    ds_read_b128 v[208:211], v248 offset:2048
    v_add_u32 v249, s54, v249
    s_branch P_next
P_g4:
    v_add_u32 v144, s54, v144
    v_add_u32 v145, s54, v145
    v_add_u32 v146, s54, v146
    v_add_u32 v147, s54, v147
    v_add_u32 v148, s54, v148
    v_add_u32 v149, s54, v149
    v_add_u32 v150, s57, v150
    v_add_u32 v151, s57, v151
    s_bitcmp1_b32 s53, 10
    s_cbranch_scc0 P_qtail
    v_mov_b32 v176, 0
    v_mov_b32 v177, 0
    v_mov_b32 v178, 0
    v_mov_b32 v179, 0
    s_nop 1
    v_mfma_f32_32x32x16_bf16 v[0:15], v[176:179], v[176:179], 0
    v_mfma_f32_32x32x16_bf16 v[16:31], v[176:179], v[176:179], 0
    v_mfma_f32_32x32x16_bf16 v[32:47], v[176:179], v[176:179], 0
    v_mfma_f32_32x32x16_bf16 v[48:63], v[176:179], v[176:179], 0
    v_mfma_f32_32x32x16_bf16 v[64:79], v[176:179], v[176:179], 0
    v_mfma_f32_32x32x16_bf16 v[80:95], v[176:179], v[176:179], 0
    v_mfma_f32_32x32x16_bf16 v[96:111], v[176:179], v[176:179], 0
    v_mfma_f32_16x16x32_bf16 v[112:115], v[176:179], v[176:179], 0
    v_mfma_f32_16x16x32_bf16 v[116:119], v[176:179], v[176:179], 0
P_next:
    v_readlane_b32 s53, v251, s55
    s_add_u32 s55, s55, 1
    s_cmp_eq_u32 s55, 64
    s_cbranch_scc1 P_sw11
P_swr11:
    s_bfe_i32 s54, s53, 0x9000e
    s_lshl_b32 s54, s54, 10
    s_ashr_i32 s57, s53, 23
    s_lshl_b32 s57, s57, 10
    s_and_b32 s56, s53, 7
    s_waitcnt lgkmcnt(0)
    s_branch P_disp
P_end:
    v_lshlrev_b32 v212, 4, v255
    v_mov_b32 v248, v212
    v_add_u32 v250, 73728, v212
    v_add_u32 v249, 61440, v249
    v_add_u32 v251, 4294905856, v249
    s_barrier
    ds_read_b128 v[244:247], v250 offset:27648
    v_mfma_f32_16x16x32_bf16 v[0:3], v[180:183], v[200:203], v[0:3]
    ds_read_b64_tr_b16 v[224:225], v251 offset:0
    v_mfma_f32_16x16x32_bf16 v[4:7], v[184:187], v[200:203], v[4:7]
    ds_read_b64_tr_b16 v[226:227], v251 offset:2560
    v_mfma_f32_16x16x32_bf16 v[8:11], v[188:191], v[200:203], v[8:11]
    ds_read_b64_tr_b16 v[228:229], v251 offset:32
    v_mfma_f32_16x16x32_bf16 v[12:15], v[192:195], v[200:203], v[12:15]
    ds_read_b64_tr_b16 v[230:231], v251 offset:2592
    v_mfma_f32_16x16x32_bf16 v[16:19], v[196:199], v[200:203], v[16:19]
    ds_read_b64_tr_b16 v[232:233], v251 offset:64
    ds_read_b128 v[200:203], v250 offset:28672
    v_mfma_f32_16x16x32_bf16 v[20:23], v[180:183], v[204:207], v[20:23]
    ds_read_b64_tr_b16 v[234:235], v251 offset:2624
    v_mfma_f32_16x16x32_bf16 v[24:27], v[184:187], v[204:207], v[24:27]
    ds_read_b64_tr_b16 v[236:237], v251 offset:96
    v_mfma_f32_16x16x32_bf16 v[28:31], v[188:191], v[204:207], v[28:31]
    ds_read_b64_tr_b16 v[238:239], v251 offset:2656
    v_mfma_f32_16x16x32_bf16 v[32:35], v[192:195], v[204:207], v[32:35]
    ds_read_b64_tr_b16 v[240:241], v251 offset:128
    v_mfma_f32_16x16x32_bf16 v[36:39], v[196:199], v[204:207], v[36:39]
    ds_read_b64_tr_b16 v[242:243], v251 offset:2688
    ds_read_b128 v[204:207], v250 offset:29696
    v_mfma_f32_16x16x32_bf16 v[40:43], v[180:183], v[208:211], v[40:43]
    v_mfma_f32_16x16x32_bf16 v[44:47], v[184:187], v[208:211], v[44:47]
    v_mfma_f32_16x16x32_bf16 v[48:51], v[188:191], v[208:211], v[48:51]
    v_mfma_f32_16x16x32_bf16 v[52:55], v[192:195], v[208:211], v[52:55]
    v_mfma_f32_16x16x32_bf16 v[56:59], v[196:199], v[208:211], v[56:59]
    ds_read_b128 v[208:211], v250 offset:30720
    s_waitcnt lgkmcnt(13)
    v_mfma_f32_16x16x32_bf16 v[60:63], v[180:183], v[244:247], v[60:63]
    v_mfma_f32_16x16x32_bf16 v[64:67], v[184:187], v[244:247], v[64:67]
    v_mfma_f32_16x16x32_bf16 v[68:71], v[188:191], v[244:247], v[68:71]
    v_mfma_f32_16x16x32_bf16 v[72:75], v[192:195], v[244:247], v[72:75]
    v_mfma_f32_16x16x32_bf16 v[76:79], v[196:199], v[244:247], v[76:79]
    ds_read_b128 v[244:247], v250 offset:31744
    s_waitcnt lgkmcnt(8)
    v_mfma_f32_16x16x32_bf16 v[80:83], v[180:183], v[200:203], v[80:83]
    v_mfma_f32_16x16x32_bf16 v[84:87], v[184:187], v[200:203], v[84:87]
    v_mfma_f32_16x16x32_bf16 v[88:91], v[188:191], v[200:203], v[88:91]
    v_mfma_f32_16x16x32_bf16 v[92:95], v[192:195], v[200:203], v[92:95]
    v_mfma_f32_16x16x32_bf16 v[96:99], v[196:199], v[200:203], v[96:99]
    ds_read_b128 v[200:203], v250 offset:32768
    s_waitcnt lgkmcnt(3)
    v_mfma_f32_16x16x32_bf16 v[100:103], v[180:183], v[204:207], v[100:103]
    v_mfma_f32_16x16x32_bf16 v[104:107], v[184:187], v[204:207], v[104:107]
    v_mfma_f32_16x16x32_bf16 v[108:111], v[188:191], v[204:207], v[108:111]
    v_mfma_f32_16x16x32_bf16 v[112:115], v[192:195], v[204:207], v[112:115]
    v_mfma_f32_16x16x32_bf16 v[116:119], v[196:199], v[204:207], v[116:119]
    s_barrier
    ds_read_b128 v[204:207], v250 offset:33792
    s_waitcnt lgkmcnt(3)
    v_mfma_f32_16x16x32_bf16 v[0:3], v[224:227], v[208:211], v[0:3]
    ds_read_b64_tr_b16 v[180:181], v249 offset:0
    v_mfma_f32_16x16x32_bf16 v[4:7], v[228:231], v[208:211], v[4:7]
    ds_read_b64_tr_b16 v[182:183], v249 offset:2560
    v_mfma_f32_16x16x32_bf16 v[8:11], v[232:235], v[208:211], v[8:11]
    ds_read_b64_tr_b16 v[184:185], v249 offset:32
    v_mfma_f32_16x16x32_bf16 v[12:15], v[236:239], v[208:211], v[12:15]
    ds_read_b64_tr_b16 v[186:187], v249 offset:2592
    v_mfma_f32_16x16x32_bf16 v[16:19], v[240:243], v[208:211], v[16:19]
    ds_read_b64_tr_b16 v[188:189], v249 offset:64
    ds_read_b128 v[208:211], v250 offset:34816
    s_waitcnt lgkmcnt(8)
    v_mfma_f32_16x16x32_bf16 v[20:23], v[224:227], v[244:247], v[20:23]
    ds_read_b64_tr_b16 v[190:191], v249 offset:2624
    v_mfma_f32_16x16x32_bf16 v[24:27], v[228:231], v[244:247], v[24:27]
    ds_read_b64_tr_b16 v[192:193], v249 offset:96
    v_mfma_f32_16x16x32_bf16 v[28:31], v[232:235], v[244:247], v[28:31]
    ds_read_b64_tr_b16 v[194:195], v249 offset:2656
    v_mfma_f32_16x16x32_bf16 v[32:35], v[236:239], v[244:247], v[32:35]
    ds_read_b64_tr_b16 v[196:197], v249 offset:128
    v_mfma_f32_16x16x32_bf16 v[36:39], v[240:243], v[244:247], v[36:39]
    ds_read_b64_tr_b16 v[198:199], v249 offset:2688
    ds_read_b128 v[244:247], v250 offset:35840
    s_waitcnt lgkmcnt(13)
    v_mfma_f32_16x16x32_bf16 v[40:43], v[224:227], v[200:203], v[40:43]
    v_mfma_f32_16x16x32_bf16 v[44:47], v[228:231], v[200:203], v[44:47]
    v_mfma_f32_16x16x32_bf16 v[48:51], v[232:235], v[200:203], v[48:51]
    v_mfma_f32_16x16x32_bf16 v[52:55], v[236:239], v[200:203], v[52:55]
    v_mfma_f32_16x16x32_bf16 v[56:59], v[240:243], v[200:203], v[56:59]
    ds_read_b128 v[200:203], v248 offset:0
    s_waitcnt lgkmcnt(13)
    v_mfma_f32_16x16x32_bf16 v[60:63], v[224:227], v[204:207], v[60:63]
    v_mfma_f32_16x16x32_bf16 v[64:67], v[228:231], v[204:207], v[64:67]
    v_mfma_f32_16x16x32_bf16 v[68:71], v[232:235], v[204:207], v[68:71]
    v_mfma_f32_16x16x32_bf16 v[72:75], v[236:239], v[204:207], v[72:75]
    v_mfma_f32_16x16x32_bf16 v[76:79], v[240:243], v[204:207], v[76:79]
    ds_read_b128 v[204:207], v248 offset:1024
    s_waitcnt lgkmcnt(8)
    v_mfma_f32_16x16x32_bf16 v[80:83], v[224:227], v[208:211], v[80:83]
    v_mfma_f32_16x16x32_bf16 v[84:87], v[228:231], v[208:211], v[84:87]
    v_mfma_f32_16x16x32_bf16 v[88:91], v[232:235], v[208:211], v[88:91]
    v_mfma_f32_16x16x32_bf16 v[92:95], v[236:239], v[208:211], v[92:95]
    v_mfma_f32_16x16x32_bf16 v[96:99], v[240:243], v[208:211], v[96:99]
    ds_read_b128 v[208:211], v248 offset:2048
    s_waitcnt lgkmcnt(3)
    v_mfma_f32_16x16x32_bf16 v[100:103], v[224:227], v[244:247], v[100:103]
    v_mfma_f32_16x16x32_bf16 v[104:107], v[228:231], v[244:247], v[104:107]
    v_mfma_f32_16x16x32_bf16 v[108:111], v[232:235], v[244:247], v[108:111]
    v_mfma_f32_16x16x32_bf16 v[112:115], v[236:239], v[244:247], v[112:115]
    v_mfma_f32_16x16x32_bf16 v[116:119], v[240:243], v[244:247], v[116:119]
    s_barrier
    ds_read_b128 v[244:247], v248 offset:3072
    s_waitcnt lgkmcnt(3)
    v_mfma_f32_16x16x32_bf16 v[0:3], v[180:183], v[200:203], v[0:3]
    ds_read_b64_tr_b16 v[224:225], v249 offset:20480
    v_mfma_f32_16x16x32_bf16 v[4:7], v[184:187], v[200:203], v[4:7]
    ds_read_b64_tr_b16 v[226:227], v249 offset:23040
    v_mfma_f32_16x16x32_bf16 v[8:11], v[188:191], v[200:203], v[8:11]
    ds_read_b64_tr_b16 v[228:229], v249 offset:20512
    v_mfma_f32_16x16x32_bf16 v[12:15], v[192:195], v[200:203], v[12:15]
    ds_read_b64_tr_b16 v[230:231], v249 offset:23072
    v_mfma_f32_16x16x32_bf16 v[16:19], v[196:199], v[200:203], v[16:19]
    ds_read_b64_tr_b16 v[232:233], v249 offset:20544
    ds_read_b128 v[200:203], v248 offset:4096
    s_waitcnt lgkmcnt(8)
    v_mfma_f32_16x16x32_bf16 v[20:23], v[180:183], v[204:207], v[20:23]
    ds_read_b64_tr_b16 v[234:235], v249 offset:23104
    v_mfma_f32_16x16x32_bf16 v[24:27], v[184:187], v[204:207], v[24:27]
    ds_read_b64_tr_b16 v[236:237], v249 offset:20576
    v_mfma_f32_16x16x32_bf16 v[28:31], v[188:191], v[204:207], v[28:31]
    ds_read_b64_tr_b16 v[238:239], v249 offset:23136
    v_mfma_f32_16x16x32_bf16 v[32:35], v[192:195], v[204:207], v[32:35]
    ds_read_b64_tr_b16 v[240:241], v249 offset:20608
    v_mfma_f32_16x16x32_bf16 v[36:39], v[196:199], v[204:207], v[36:39]
    ds_read_b64_tr_b16 v[242:243], v249 offset:23168
    ds_read_b128 v[204:207], v248 offset:5120
    s_waitcnt lgkmcnt(13)
    v_mfma_f32_16x16x32_bf16 v[40:43], v[180:183], v[208:211], v[40:43]
    v_mfma_f32_16x16x32_bf16 v[44:47], v[184:187], v[208:211], v[44:47]
    v_mfma_f32_16x16x32_bf16 v[48:51], v[188:191], v[208:211], v[48:51]
    v_mfma_f32_16x16x32_bf16 v[52:55], v[192:195], v[208:211], v[52:55]
    v_mfma_f32_16x16x32_bf16 v[56:59], v[196:199], v[208:211], v[56:59]
    ds_read_b128 v[208:211], v248 offset:6144
    s_waitcnt lgkmcnt(13)
    v_mfma_f32_16x16x32_bf16 v[60:63], v[180:183], v[244:247], v[60:63]
    v_mfma_f32_16x16x32_bf16 v[64:67], v[184:187], v[244:247], v[64:67]
    v_mfma_f32_16x16x32_bf16 v[68:71], v[188:191], v[244:247], v[68:71]
    v_mfma_f32_16x16x32_bf16 v[72:75], v[192:195], v[244:247], v[72:75]
    v_mfma_f32_16x16x32_bf16 v[76:79], v[196:199], v[244:247], v[76:79]
    ds_read_b128 v[244:247], v248 offset:7168
    s_waitcnt lgkmcnt(8)
    v_mfma_f32_16x16x32_bf16 v[80:83], v[180:183], v[200:203], v[80:83]
    v_mfma_f32_16x16x32_bf16 v[84:87], v[184:187], v[200:203], v[84:87]
    v_mfma_f32_16x16x32_bf16 v[88:91], v[188:191], v[200:203], v[88:91]
    v_mfma_f32_16x16x32_bf16 v[92:95], v[192:195], v[200:203], v[92:95]
    v_mfma_f32_16x16x32_bf16 v[96:99], v[196:199], v[200:203], v[96:99]
    ds_read_b128 v[200:203], v248 offset:8192
    s_waitcnt lgkmcnt(3)
    v_mfma_f32_16x16x32_bf16 v[100:103], v[180:183], v[204:207], v[100:103]
    v_mfma_f32_16x16x32_bf16 v[104:107], v[184:187], v[204:207], v[104:107]
    v_mfma_f32_16x16x32_bf16 v[108:111], v[188:191], v[204:207], v[108:111]
    v_mfma_f32_16x16x32_bf16 v[112:115], v[192:195], v[204:207], v[112:115]
    v_mfma_f32_16x16x32_bf16 v[116:119], v[196:199], v[204:207], v[116:119]
    s_barrier
    ds_read_b128 v[204:207], v248 offset:9216
    s_waitcnt lgkmcnt(3)
    v_mfma_f32_16x16x32_bf16 v[0:3], v[224:227], v[208:211], v[0:3]
    ds_read_b64_tr_b16 v[180:181], v251 offset:0
    v_mfma_f32_16x16x32_bf16 v[4:7], v[228:231], v[208:211], v[4:7]
    ds_read_b64_tr_b16 v[182:183], v251 offset:2560
    v_mfma_f32_16x16x32_bf16 v[8:11], v[232:235], v[208:211], v[8:11]
    ds_read_b64_tr_b16 v[184:185], v251 offset:32
    v_mfma_f32_16x16x32_bf16 v[12:15], v[236:239], v[208:211], v[12:15]
    ds_read_b64_tr_b16 v[186:187], v251 offset:2592
    v_mfma_f32_16x16x32_bf16 v[16:19], v[240:243], v[208:211], v[16:19]
    ds_read_b64_tr_b16 v[188:189], v251 offset:64
    ds_read_b128 v[208:211], v248 offset:10240
    s_waitcnt lgkmcnt(8)
    v_mfma_f32_16x16x32_bf16 v[20:23], v[224:227], v[244:247], v[20:23]
    ds_read_b64_tr_b16 v[190:191], v251 offset:2624
    v_mfma_f32_16x16x32_bf16 v[24:27], v[228:231], v[244:247], v[24:27]
    ds_read_b64_tr_b16 v[192:193], v251 offset:96
    v_mfma_f32_16x16x32_bf16 v[28:31], v[232:235], v[244:247], v[28:31]
    ds_read_b64_tr_b16 v[194:195], v251 offset:2656
    v_mfma_f32_16x16x32_bf16 v[32:35], v[236:239], v[244:247], v[32:35]
    ds_read_b64_tr_b16 v[196:197], v251 offset:128
    v_mfma_f32_16x16x32_bf16 v[36:39], v[240:243], v[244:247], v[36:39]
    ds_read_b64_tr_b16 v[198:199], v251 offset:2688
    ds_read_b128 v[244:247], v248 offset:11264
    s_waitcnt lgkmcnt(13)
    v_mfma_f32_16x16x32_bf16 v[40:43], v[224:227], v[200:203], v[40:43]
    v_mfma_f32_16x16x32_bf16 v[44:47], v[228:231], v[200:203], v[44:47]
    v_mfma_f32_16x16x32_bf16 v[48:51], v[232:235], v[200:203], v[48:51]
    v_mfma_f32_16x16x32_bf16 v[52:55], v[236:239], v[200:203], v[52:55]
    v_mfma_f32_16x16x32_bf16 v[56:59], v[240:243], v[200:203], v[56:59]
    ds_read_b128 v[200:203], v248 offset:12288
    s_waitcnt lgkmcnt(13)
    v_mfma_f32_16x16x32_bf16 v[60:63], v[224:227], v[204:207], v[60:63]
    v_mfma_f32_16x16x32_bf16 v[64:67], v[228:231], v[204:207], v[64:67]
    v_mfma_f32_16x16x32_bf16 v[68:71], v[232:235], v[204:207], v[68:71]
    v_mfma_f32_16x16x32_bf16 v[72:75], v[236:239], v[204:207], v[72:75]
    v_mfma_f32_16x16x32_bf16 v[76:79], v[240:243], v[204:207], v[76:79]
    ds_read_b128 v[204:207], v248 offset:13312
    s_waitcnt lgkmcnt(8)
    v_mfma_f32_16x16x32_bf16 v[80:83], v[224:227], v[208:211], v[80:83]
    v_mfma_f32_16x16x32_bf16 v[84:87], v[228:231], v[208:211], v[84:87]
    v_mfma_f32_16x16x32_bf16 v[88:91], v[232:235], v[208:211], v[88:91]
    v_mfma_f32_16x16x32_bf16 v[92:95], v[236:239], v[208:211], v[92:95]
    v_mfma_f32_16x16x32_bf16 v[96:99], v[240:243], v[208:211], v[96:99]
    ds_read_b128 v[208:211], v248 offset:14336
    s_waitcnt lgkmcnt(3)
    v_mfma_f32_16x16x32_bf16 v[100:103], v[224:227], v[244:247], v[100:103]
    v_mfma_f32_16x16x32_bf16 v[104:107], v[228:231], v[244:247], v[104:107]
    v_mfma_f32_16x16x32_bf16 v[108:111], v[232:235], v[244:247], v[108:111]
    v_mfma_f32_16x16x32_bf16 v[112:115], v[236:239], v[244:247], v[112:115]
    v_mfma_f32_16x16x32_bf16 v[116:119], v[240:243], v[244:247], v[116:119]
    s_barrier
    ds_read_b128 v[244:247], v248 offset:15360
    s_waitcnt lgkmcnt(3)
    v_mfma_f32_16x16x32_bf16 v[0:3], v[180:183], v[200:203], v[0:3]
    ds_read_b64_tr_b16 v[224:225], v249 offset:0
    v_mfma_f32_16x16x32_bf16 v[4:7], v[184:187], v[200:203], v[4:7]
    ds_read_b64_tr_b16 v[226:227], v249 offset:2560
    v_mfma_f32_16x16x32_bf16 v[8:11], v[188:191], v[200:203], v[8:11]
    ds_read_b64_tr_b16 v[228:229], v249 offset:32
    v_mfma_f32_16x16x32_bf16 v[12:15], v[192:195], v[200:203], v[12:15]
    ds_read_b64_tr_b16 v[230:231], v249 offset:2592
    v_mfma_f32_16x16x32_bf16 v[16:19], v[196:199], v[200:203], v[16:19]
    ds_read_b64_tr_b16 v[232:233], v249 offset:64
    ds_read_b128 v[200:203], v248 offset:16384
    s_waitcnt lgkmcnt(8)
    v_mfma_f32_16x16x32_bf16 v[20:23], v[180:183], v[204:207], v[20:23]
    ds_read_b64_tr_b16 v[234:235], v249 offset:2624
    v_mfma_f32_16x16x32_bf16 v[24:27], v[184:187], v[204:207], v[24:27]
    ds_read_b64_tr_b16 v[236:237], v249 offset:96
    v_mfma_f32_16x16x32_bf16 v[28:31], v[188:191], v[204:207], v[28:31]
    ds_read_b64_tr_b16 v[238:239], v249 offset:2656
    v_mfma_f32_16x16x32_bf16 v[32:35], v[192:195], v[204:207], v[32:35]
    ds_read_b64_tr_b16 v[240:241], v249 offset:128
    v_mfma_f32_16x16x32_bf16 v[36:39], v[196:199], v[204:207], v[36:39]
    ds_read_b64_tr_b16 v[242:243], v249 offset:2688
    ds_read_b128 v[204:207], v248 offset:17408
    s_waitcnt lgkmcnt(13)
    v_mfma_f32_16x16x32_bf16 v[40:43], v[180:183], v[208:211], v[40:43]
    v_mfma_f32_16x16x32_bf16 v[44:47], v[184:187], v[208:211], v[44:47]
    v_mfma_f32_16x16x32_bf16 v[48:51], v[188:191], v[208:211], v[48:51]
    v_mfma_f32_16x16x32_bf16 v[52:55], v[192:195], v[208:211], v[52:55]
    v_mfma_f32_16x16x32_bf16 v[56:59], v[196:199], v[208:211], v[56:59]
    ds_read_b128 v[208:211], v248 offset:18432
    s_waitcnt lgkmcnt(13)
    v_mfma_f32_16x16x32_bf16 v[60:63], v[180:183], v[244:247], v[60:63]
    v_mfma_f32_16x16x32_bf16 v[64:67], v[184:187], v[244:247], v[64:67]
    v_mfma_f32_16x16x32_bf16 v[68:71], v[188:191], v[244:247], v[68:71]
    v_mfma_f32_16x16x32_bf16 v[72:75], v[192:195], v[244:247], v[72:75]
    v_mfma_f32_16x16x32_bf16 v[76:79], v[196:199], v[244:247], v[76:79]
    ds_read_b128 v[244:247], v248 offset:19456
    s_waitcnt lgkmcnt(8)
    v_mfma_f32_16x16x32_bf16 v[80:83], v[180:183], v[200:203], v[80:83]
    v_mfma_f32_16x16x32_bf16 v[84:87], v[184:187], v[200:203], v[84:87]
    v_mfma_f32_16x16x32_bf16 v[88:91], v[188:191], v[200:203], v[88:91]
    v_mfma_f32_16x16x32_bf16 v[92:95], v[192:195], v[200:203], v[92:95]
    v_mfma_f32_16x16x32_bf16 v[96:99], v[196:199], v[200:203], v[96:99]
    ds_read_b128 v[200:203], v248 offset:20480
    s_waitcnt lgkmcnt(3)
    v_mfma_f32_16x16x32_bf16 v[100:103], v[180:183], v[204:207], v[100:103]
    v_mfma_f32_16x16x32_bf16 v[104:107], v[184:187], v[204:207], v[104:107]
    v_mfma_f32_16x16x32_bf16 v[108:111], v[188:191], v[204:207], v[108:111]
    v_mfma_f32_16x16x32_bf16 v[112:115], v[192:195], v[204:207], v[112:115]
    v_mfma_f32_16x16x32_bf16 v[116:119], v[196:199], v[204:207], v[116:119]
    s_barrier
    ds_read_b128 v[204:207], v248 offset:21504
    s_waitcnt lgkmcnt(3)
    v_mfma_f32_16x16x32_bf16 v[0:3], v[224:227], v[208:211], v[0:3]
    ds_read_b64_tr_b16 v[180:181], v249 offset:20480
    v_mfma_f32_16x16x32_bf16 v[4:7], v[228:231], v[208:211], v[4:7]
    ds_read_b64_tr_b16 v[182:183], v249 offset:23040
    v_mfma_f32_16x16x32_bf16 v[8:11], v[232:235], v[208:211], v[8:11]
    ds_read_b64_tr_b16 v[184:185], v249 offset:20512
    v_mfma_f32_16x16x32_bf16 v[12:15], v[236:239], v[208:211], v[12:15]
    ds_read_b64_tr_b16 v[186:187], v249 offset:23072
    v_mfma_f32_16x16x32_bf16 v[16:19], v[240:243], v[208:211], v[16:19]
    ds_read_b64_tr_b16 v[188:189], v249 offset:20544
    ds_read_b128 v[208:211], v248 offset:22528
    s_waitcnt lgkmcnt(8)
    v_mfma_f32_16x16x32_bf16 v[20:23], v[224:227], v[244:247], v[20:23]
    ds_read_b64_tr_b16 v[190:191], v249 offset:23104
    v_mfma_f32_16x16x32_bf16 v[24:27], v[228:231], v[244:247], v[24:27]
    ds_read_b64_tr_b16 v[192:193], v249 offset:20576
    v_mfma_f32_16x16x32_bf16 v[28:31], v[232:235], v[244:247], v[28:31]
    ds_read_b64_tr_b16 v[194:195], v249 offset:23136
    v_mfma_f32_16x16x32_bf16 v[32:35], v[236:239], v[244:247], v[32:35]
    ds_read_b64_tr_b16 v[196:197], v249 offset:20608
    v_mfma_f32_16x16x32_bf16 v[36:39], v[240:243], v[244:247], v[36:39]
    ds_read_b64_tr_b16 v[198:199], v249 offset:23168
    ds_read_b128 v[244:247], v248 offset:23552
    s_waitcnt lgkmcnt(13)
    v_mfma_f32_16x16x32_bf16 v[40:43], v[224:227], v[200:203], v[40:43]
    v_mfma_f32_16x16x32_bf16 v[44:47], v[228:231], v[200:203], v[44:47]
    v_mfma_f32_16x16x32_bf16 v[48:51], v[232:235], v[200:203], v[48:51]
    v_mfma_f32_16x16x32_bf16 v[52:55], v[236:239], v[200:203], v[52:55]
    v_mfma_f32_16x16x32_bf16 v[56:59], v[240:243], v[200:203], v[56:59]
    ds_read_b128 v[200:203], v248 offset:24576
    s_waitcnt lgkmcnt(13)
    v_mfma_f32_16x16x32_bf16 v[60:63], v[224:227], v[204:207], v[60:63]
    v_mfma_f32_16x16x32_bf16 v[64:67], v[228:231], v[204:207], v[64:67]
    v_mfma_f32_16x16x32_bf16 v[68:71], v[232:235], v[204:207], v[68:71]
    v_mfma_f32_16x16x32_bf16 v[72:75], v[236:239], v[204:207], v[72:75]
    v_mfma_f32_16x16x32_bf16 v[76:79], v[240:243], v[204:207], v[76:79]
    ds_read_b128 v[204:207], v248 offset:25600
    s_waitcnt lgkmcnt(8)
    v_mfma_f32_16x16x32_bf16 v[80:83], v[224:227], v[208:211], v[80:83]
    v_mfma_f32_16x16x32_bf16 v[84:87], v[228:231], v[208:211], v[84:87]
    v_mfma_f32_16x16x32_bf16 v[88:91], v[232:235], v[208:211], v[88:91]
    v_mfma_f32_16x16x32_bf16 v[92:95], v[236:239], v[208:211], v[92:95]
    v_mfma_f32_16x16x32_bf16 v[96:99], v[240:243], v[208:211], v[96:99]
    ds_read_b128 v[208:211], v248 offset:26624
    s_waitcnt lgkmcnt(3)
    v_mfma_f32_16x16x32_bf16 v[100:103], v[224:227], v[244:247], v[100:103]
    v_mfma_f32_16x16x32_bf16 v[104:107], v[228:231], v[244:247], v[104:107]
    v_mfma_f32_16x16x32_bf16 v[108:111], v[232:235], v[244:247], v[108:111]
    v_mfma_f32_16x16x32_bf16 v[112:115], v[236:239], v[244:247], v[112:115]
    v_mfma_f32_16x16x32_bf16 v[116:119], v[240:243], v[244:247], v[116:119]
    s_barrier
    ds_read_b128 v[244:247], v248 offset:27648
    s_waitcnt lgkmcnt(3)
    v_mfma_f32_16x16x32_bf16 v[0:3], v[180:183], v[200:203], v[0:3]
    ds_read_b64_tr_b16 v[224:225], v251 offset:0
    v_mfma_f32_16x16x32_bf16 v[4:7], v[184:187], v[200:203], v[4:7]
    ds_read_b64_tr_b16 v[226:227], v251 offset:2560
    v_mfma_f32_16x16x32_bf16 v[8:11], v[188:191], v[200:203], v[8:11]
    ds_read_b64_tr_b16 v[228:229], v251 offset:32
    v_mfma_f32_16x16x32_bf16 v[12:15], v[192:195], v[200:203], v[12:15]
    ds_read_b64_tr_b16 v[230:231], v251 offset:2592
    v_mfma_f32_16x16x32_bf16 v[16:19], v[196:199], v[200:203], v[16:19]
    ds_read_b64_tr_b16 v[232:233], v251 offset:64
    ds_read_b128 v[200:203], v248 offset:28672
    s_waitcnt lgkmcnt(8)
    v_mfma_f32_16x16x32_bf16 v[20:23], v[180:183], v[204:207], v[20:23]
    ds_read_b64_tr_b16 v[234:235], v251 offset:2624
    v_mfma_f32_16x16x32_bf16 v[24:27], v[184:187], v[204:207], v[24:27]
    ds_read_b64_tr_b16 v[236:237], v251 offset:96
    v_mfma_f32_16x16x32_bf16 v[28:31], v[188:191], v[204:207], v[28:31]
    ds_read_b64_tr_b16 v[238:239], v251 offset:2656
    v_mfma_f32_16x16x32_bf16 v[32:35], v[192:195], v[204:207], v[32:35]
    ds_read_b64_tr_b16 v[240:241], v251 offset:128
    v_mfma_f32_16x16x32_bf16 v[36:39], v[196:199], v[204:207], v[36:39]
    ds_read_b64_tr_b16 v[242:243], v251 offset:2688
    ds_read_b128 v[204:207], v248 offset:29696
    s_waitcnt lgkmcnt(13)
    v_mfma_f32_16x16x32_bf16 v[40:43], v[180:183], v[208:211], v[40:43]
    v_mfma_f32_16x16x32_bf16 v[44:47], v[184:187], v[208:211], v[44:47]
    v_mfma_f32_16x16x32_bf16 v[48:51], v[188:191], v[208:211], v[48:51]
    v_mfma_f32_16x16x32_bf16 v[52:55], v[192:195], v[208:211], v[52:55]
    v_mfma_f32_16x16x32_bf16 v[56:59], v[196:199], v[208:211], v[56:59]
    ds_read_b128 v[208:211], v248 offset:30720
    s_waitcnt lgkmcnt(13)
    v_mfma_f32_16x16x32_bf16 v[60:63], v[180:183], v[244:247], v[60:63]
    v_mfma_f32_16x16x32_bf16 v[64:67], v[184:187], v[244:247], v[64:67]
    v_mfma_f32_16x16x32_bf16 v[68:71], v[188:191], v[244:247], v[68:71]
    v_mfma_f32_16x16x32_bf16 v[72:75], v[192:195], v[244:247], v[72:75]
    v_mfma_f32_16x16x32_bf16 v[76:79], v[196:199], v[244:247], v[76:79]
    ds_read_b128 v[244:247], v248 offset:31744
    s_waitcnt lgkmcnt(8)
    v_mfma_f32_16x16x32_bf16 v[80:83], v[180:183], v[200:203], v[80:83]
    v_mfma_f32_16x16x32_bf16 v[84:87], v[184:187], v[200:203], v[84:87]
    v_mfma_f32_16x16x32_bf16 v[88:91], v[188:191], v[200:203], v[88:91]
    v_mfma_f32_16x16x32_bf16 v[92:95], v[192:195], v[200:203], v[92:95]
    v_mfma_f32_16x16x32_bf16 v[96:99], v[196:199], v[200:203], v[96:99]
    ds_read_b128 v[200:203], v248 offset:32768
    s_waitcnt lgkmcnt(3)
    v_mfma_f32_16x16x32_bf16 v[100:103], v[180:183], v[204:207], v[100:103]
    v_mfma_f32_16x16x32_bf16 v[104:107], v[184:187], v[204:207], v[104:107]
    v_mfma_f32_16x16x32_bf16 v[108:111], v[188:191], v[204:207], v[108:111]
    v_mfma_f32_16x16x32_bf16 v[112:115], v[192:195], v[204:207], v[112:115]
    v_mfma_f32_16x16x32_bf16 v[116:119], v[196:199], v[204:207], v[116:119]
    s_barrier
    ds_read_b128 v[204:207], v248 offset:33792
    s_waitcnt lgkmcnt(3)
    v_mfma_f32_16x16x32_bf16 v[0:3], v[224:227], v[208:211], v[0:3]
    ds_read_b64_tr_b16 v[180:181], v249 offset:0
    v_mfma_f32_16x16x32_bf16 v[4:7], v[228:231], v[208:211], v[4:7]
    ds_read_b64_tr_b16 v[182:183], v249 offset:2560
    v_mfma_f32_16x16x32_bf16 v[8:11], v[232:235], v[208:211], v[8:11]
    ds_read_b64_tr_b16 v[184:185], v249 offset:32
    v_mfma_f32_16x16x32_bf16 v[12:15], v[236:239], v[208:211], v[12:15]
    ds_read_b64_tr_b16 v[186:187], v249 offset:2592
    v_mfma_f32_16x16x32_bf16 v[16:19], v[240:243], v[208:211], v[16:19]
    ds_read_b64_tr_b16 v[188:189], v249 offset:64
    ds_read_b128 v[208:211], v248 offset:34816
    s_waitcnt lgkmcnt(8)
    v_mfma_f32_16x16x32_bf16 v[20:23], v[224:227], v[244:247], v[20:23]
    ds_read_b64_tr_b16 v[190:191], v249 offset:2624
    v_mfma_f32_16x16x32_bf16 v[24:27], v[228:231], v[244:247], v[24:27]
    ds_read_b64_tr_b16 v[192:193], v249 offset:96
    v_cvt_pk_bf16_f32 v176, v0, v1
    v_cvt_pk_bf16_f32 v177, v2, v3
    v_cvt_pk_bf16_f32 v178, v4, v5
    v_cvt_pk_bf16_f32 v179, v6, v7
    v_mfma_f32_16x16x32_bf16 v[28:31], v[232:235], v[244:247], v[28:31]
    ds_read_b64_tr_b16 v[194:195], v249 offset:2656
    v_lshlrev_b32 v0, 16, v220
    v_and_b32 v1, 0xffff0000, v220
    v_lshlrev_b32 v2, 16, v221
    v_and_b32 v3, 0xffff0000, v221
    v_mfma_f32_16x16x32_bf16 v[32:35], v[236:239], v[244:247], v[32:35]
    ds_read_b64_tr_b16 v[196:197], v249 offset:128
    v_lshlrev_b32 v4, 16, v222
    v_and_b32 v5, 0xffff0000, v222
    v_lshlrev_b32 v6, 16, v223
    v_and_b32 v7, 0xffff0000, v223
    v_mfma_f32_16x16x32_bf16 v[36:39], v[240:243], v[244:247], v[36:39]
    ds_read_b64_tr_b16 v[198:199], v249 offset:2688
    v_cvt_pk_bf16_f32 v220, v8, v9
    v_cvt_pk_bf16_f32 v221, v10, v11
    v_cvt_pk_bf16_f32 v222, v12, v13
    ds_read_b128 v[244:247], v248 offset:35840
    s_waitcnt lgkmcnt(13)
    v_mfma_f32_16x16x32_bf16 v[40:43], v[224:227], v[200:203], v[40:43]
    v_cvt_pk_bf16_f32 v223, v14, v15
    v_lshlrev_b32 v8, 16, v120
    v_and_b32 v9, 0xffff0000, v120
    v_lshlrev_b32 v10, 16, v121
    v_mfma_f32_16x16x32_bf16 v[44:47], v[228:231], v[200:203], v[44:47]
    v_and_b32 v11, 0xffff0000, v121
    v_lshlrev_b32 v12, 16, v122
    v_and_b32 v13, 0xffff0000, v122
    v_lshlrev_b32 v14, 16, v123
    v_mfma_f32_16x16x32_bf16 v[48:51], v[232:235], v[200:203], v[48:51]
    s_add_u32 s49, s68, 0
    buffer_store_dwordx4 v[176:179], v212, s[24:27], s49 offen sc1
    v_and_b32 v15, 0xffff0000, v123
    v_cvt_pk_bf16_f32 v120, v16, v17
    v_cvt_pk_bf16_f32 v121, v18, v19
    v_mfma_f32_16x16x32_bf16 v[52:55], v[236:239], v[200:203], v[52:55]
    v_cvt_pk_bf16_f32 v122, v20, v21
    v_cvt_pk_bf16_f32 v123, v22, v23
    v_lshlrev_b32 v16, 16, v124
    v_and_b32 v17, 0xffff0000, v124
    v_mfma_f32_16x16x32_bf16 v[56:59], v[240:243], v[200:203], v[56:59]
    v_lshlrev_b32 v18, 16, v125
    v_and_b32 v19, 0xffff0000, v125
    v_lshlrev_b32 v20, 16, v126
    v_and_b32 v21, 0xffff0000, v126
    ds_read_b128 v[200:203], v250 offset:18432
    s_waitcnt lgkmcnt(13)
    v_mfma_f32_16x16x32_bf16 v[60:63], v[224:227], v[204:207], v[60:63]
    v_lshlrev_b32 v22, 16, v127
    v_and_b32 v23, 0xffff0000, v127
    v_cvt_pk_bf16_f32 v124, v24, v25
    v_mfma_f32_16x16x32_bf16 v[64:67], v[228:231], v[204:207], v[64:67]
    v_cvt_pk_bf16_f32 v125, v26, v27
    v_cvt_pk_bf16_f32 v126, v28, v29
    v_cvt_pk_bf16_f32 v127, v30, v31
    v_lshlrev_b32 v24, 16, v128
    v_mfma_f32_16x16x32_bf16 v[68:71], v[232:235], v[204:207], v[68:71]
    v_and_b32 v25, 0xffff0000, v128
    v_lshlrev_b32 v26, 16, v129
    v_and_b32 v27, 0xffff0000, v129
    v_lshlrev_b32 v28, 16, v130
    v_mfma_f32_16x16x32_bf16 v[72:75], v[236:239], v[204:207], v[72:75]
    s_add_u32 s49, s68, 8192
    buffer_store_dwordx4 v[220:223], v212, s[24:27], s49 offen sc1
    v_and_b32 v29, 0xffff0000, v130
    v_lshlrev_b32 v30, 16, v131
    v_and_b32 v31, 0xffff0000, v131
    v_mfma_f32_16x16x32_bf16 v[76:79], v[240:243], v[204:207], v[76:79]
    v_cvt_pk_bf16_f32 v128, v32, v33
    v_cvt_pk_bf16_f32 v129, v34, v35
    v_cvt_pk_bf16_f32 v130, v36, v37
    v_cvt_pk_bf16_f32 v131, v38, v39
    ds_read_b128 v[204:207], v250 offset:19456
    s_waitcnt lgkmcnt(8)
    v_mfma_f32_16x16x32_bf16 v[80:83], v[224:227], v[208:211], v[80:83]
    v_lshlrev_b32 v32, 16, v132
    v_and_b32 v33, 0xffff0000, v132
    v_lshlrev_b32 v34, 16, v133
    v_and_b32 v35, 0xffff0000, v133
    v_mfma_f32_16x16x32_bf16 v[84:87], v[228:231], v[208:211], v[84:87]
    v_lshlrev_b32 v36, 16, v134
    v_and_b32 v37, 0xffff0000, v134
    v_lshlrev_b32 v38, 16, v135
    v_and_b32 v39, 0xffff0000, v135
    v_mfma_f32_16x16x32_bf16 v[88:91], v[232:235], v[208:211], v[88:91]
    v_cvt_pk_bf16_f32 v132, v40, v41
    v_cvt_pk_bf16_f32 v133, v42, v43
    v_cvt_pk_bf16_f32 v134, v44, v45
    v_mfma_f32_16x16x32_bf16 v[92:95], v[236:239], v[208:211], v[92:95]
    v_cvt_pk_bf16_f32 v135, v46, v47
    v_lshlrev_b32 v40, 16, v136
    v_and_b32 v41, 0xffff0000, v136
    v_lshlrev_b32 v42, 16, v137
    v_mfma_f32_16x16x32_bf16 v[96:99], v[240:243], v[208:211], v[96:99]
    s_add_u32 s49, s68, 16384
    buffer_store_dwordx4 v[120:123], v212, s[24:27], s49 offen sc1
    v_and_b32 v43, 0xffff0000, v137
    v_lshlrev_b32 v44, 16, v138
    v_and_b32 v45, 0xffff0000, v138
    v_lshlrev_b32 v46, 16, v139
    ds_read_b128 v[208:211], v250 offset:20480
    s_waitcnt lgkmcnt(3)
    v_mfma_f32_16x16x32_bf16 v[100:103], v[224:227], v[244:247], v[100:103]
    v_and_b32 v47, 0xffff0000, v139
    v_cvt_pk_bf16_f32 v136, v48, v49
    v_cvt_pk_bf16_f32 v137, v50, v51
    v_mfma_f32_16x16x32_bf16 v[104:107], v[228:231], v[244:247], v[104:107]
    v_cvt_pk_bf16_f32 v138, v52, v53
    v_cvt_pk_bf16_f32 v139, v54, v55
    v_lshlrev_b32 v48, 16, v140
    v_and_b32 v49, 0xffff0000, v140
    v_mfma_f32_16x16x32_bf16 v[108:111], v[232:235], v[244:247], v[108:111]
    v_lshlrev_b32 v50, 16, v141
    v_and_b32 v51, 0xffff0000, v141
    v_lshlrev_b32 v52, 16, v142
    v_and_b32 v53, 0xffff0000, v142
    v_mfma_f32_16x16x32_bf16 v[112:115], v[236:239], v[244:247], v[112:115]
    v_lshlrev_b32 v54, 16, v143
    v_and_b32 v55, 0xffff0000, v143
    v_cvt_pk_bf16_f32 v140, v56, v57
    v_mfma_f32_16x16x32_bf16 v[116:119], v[240:243], v[244:247], v[116:119]
    v_cvt_pk_bf16_f32 v141, v58, v59
    v_cvt_pk_bf16_f32 v142, v60, v61
    v_cvt_pk_bf16_f32 v143, v62, v63
    v_lshlrev_b32 v56, 16, v144
    s_barrier
    ds_read_b128 v[244:247], v250 offset:21504
    s_waitcnt lgkmcnt(3)
    v_mfma_f32_16x16x32_bf16 v[0:3], v[180:183], v[200:203], v[0:3]
    ds_read_b64_tr_b16 v[224:225], v249 offset:20480
    v_and_b32 v57, 0xffff0000, v144
    v_lshlrev_b32 v58, 16, v145
    v_and_b32 v59, 0xffff0000, v145
    v_lshlrev_b32 v60, 16, v146
    v_mfma_f32_16x16x32_bf16 v[4:7], v[184:187], v[200:203], v[4:7]
    ds_read_b64_tr_b16 v[226:227], v249 offset:23040
    v_and_b32 v61, 0xffff0000, v146
    v_lshlrev_b32 v62, 16, v147
    v_and_b32 v63, 0xffff0000, v147
    v_mfma_f32_16x16x32_bf16 v[8:11], v[188:191], v[200:203], v[8:11]
    ds_read_b64_tr_b16 v[228:229], v249 offset:20512
    v_cvt_pk_bf16_f32 v144, v64, v65
    v_cvt_pk_bf16_f32 v145, v66, v67
    v_cvt_pk_bf16_f32 v146, v68, v69
    v_cvt_pk_bf16_f32 v147, v70, v71
    v_mfma_f32_16x16x32_bf16 v[12:15], v[192:195], v[200:203], v[12:15]
    ds_read_b64_tr_b16 v[230:231], v249 offset:23072
    v_lshlrev_b32 v64, 16, v148
    v_and_b32 v65, 0xffff0000, v148
    v_lshlrev_b32 v66, 16, v149
    v_and_b32 v67, 0xffff0000, v149
    v_mfma_f32_16x16x32_bf16 v[16:19], v[196:199], v[200:203], v[16:19]
    ds_read_b64_tr_b16 v[232:233], v249 offset:20544
    v_lshlrev_b32 v68, 16, v150
    v_and_b32 v69, 0xffff0000, v150
    v_lshlrev_b32 v70, 16, v151
    v_and_b32 v71, 0xffff0000, v151
    ds_read_b128 v[200:203], v250 offset:22528
    s_waitcnt lgkmcnt(8)
    v_mfma_f32_16x16x32_bf16 v[20:23], v[180:183], v[204:207], v[20:23]
    ds_read_b64_tr_b16 v[234:235], v249 offset:23104
    v_cvt_pk_bf16_f32 v148, v72, v73
    v_cvt_pk_bf16_f32 v149, v74, v75
    v_cvt_pk_bf16_f32 v150, v76, v77
    v_mfma_f32_16x16x32_bf16 v[24:27], v[184:187], v[204:207], v[24:27]
    ds_read_b64_tr_b16 v[236:237], v249 offset:20576
    v_cvt_pk_bf16_f32 v151, v78, v79
    v_lshlrev_b32 v72, 16, v152
    v_and_b32 v73, 0xffff0000, v152
    v_lshlrev_b32 v74, 16, v153
    v_mfma_f32_16x16x32_bf16 v[28:31], v[188:191], v[204:207], v[28:31]
    ds_read_b64_tr_b16 v[238:239], v249 offset:23136
    v_and_b32 v75, 0xffff0000, v153
    v_lshlrev_b32 v76, 16, v154
    v_and_b32 v77, 0xffff0000, v154
    v_lshlrev_b32 v78, 16, v155
    v_mfma_f32_16x16x32_bf16 v[32:35], v[192:195], v[204:207], v[32:35]
    ds_read_b64_tr_b16 v[240:241], v249 offset:20608
    v_and_b32 v79, 0xffff0000, v155
    v_cvt_pk_bf16_f32 v152, v80, v81
    v_cvt_pk_bf16_f32 v153, v82, v83
    v_mfma_f32_16x16x32_bf16 v[36:39], v[196:199], v[204:207], v[36:39]
    ds_read_b64_tr_b16 v[242:243], v249 offset:23168
    v_cvt_pk_bf16_f32 v154, v84, v85
    v_cvt_pk_bf16_f32 v155, v86, v87
    v_lshlrev_b32 v80, 16, v156
    v_and_b32 v81, 0xffff0000, v156
    ds_read_b128 v[204:207], v250 offset:23552
    s_waitcnt lgkmcnt(13)
    v_mfma_f32_16x16x32_bf16 v[40:43], v[180:183], v[208:211], v[40:43]
    v_lshlrev_b32 v82, 16, v157
    v_and_b32 v83, 0xffff0000, v157
    v_lshlrev_b32 v84, 16, v158
    v_and_b32 v85, 0xffff0000, v158
    v_mfma_f32_16x16x32_bf16 v[44:47], v[184:187], v[208:211], v[44:47]
    v_lshlrev_b32 v86, 16, v159
    v_and_b32 v87, 0xffff0000, v159
    v_cvt_pk_bf16_f32 v156, v88, v89
    v_mfma_f32_16x16x32_bf16 v[48:51], v[188:191], v[208:211], v[48:51]
    s_add_u32 s49, s68, 24576
    buffer_store_dwordx4 v[124:127], v212, s[24:27], s49 offen sc1
    v_cvt_pk_bf16_f32 v157, v90, v91
    v_cvt_pk_bf16_f32 v158, v92, v93
    v_cvt_pk_bf16_f32 v159, v94, v95
    v_lshlrev_b32 v88, 16, v160
    v_mfma_f32_16x16x32_bf16 v[52:55], v[192:195], v[208:211], v[52:55]
    v_and_b32 v89, 0xffff0000, v160
    v_lshlrev_b32 v90, 16, v161
    v_and_b32 v91, 0xffff0000, v161
    v_lshlrev_b32 v92, 16, v162
    v_mfma_f32_16x16x32_bf16 v[56:59], v[196:199], v[208:211], v[56:59]
    v_and_b32 v93, 0xffff0000, v162
    v_lshlrev_b32 v94, 16, v163
    v_and_b32 v95, 0xffff0000, v163
    ds_read_b128 v[208:211], v250 offset:24576
    s_waitcnt lgkmcnt(13)
    v_mfma_f32_16x16x32_bf16 v[60:63], v[180:183], v[244:247], v[60:63]
    v_cvt_pk_bf16_f32 v160, v96, v97
    v_cvt_pk_bf16_f32 v161, v98, v99
    v_cvt_pk_bf16_f32 v162, v100, v101
    v_cvt_pk_bf16_f32 v163, v102, v103
    v_mfma_f32_16x16x32_bf16 v[64:67], v[184:187], v[244:247], v[64:67]
    v_lshlrev_b32 v96, 16, v164
    v_and_b32 v97, 0xffff0000, v164
    v_lshlrev_b32 v98, 16, v165
    v_and_b32 v99, 0xffff0000, v165
    v_mfma_f32_16x16x32_bf16 v[68:71], v[188:191], v[244:247], v[68:71]
    v_lshlrev_b32 v100, 16, v166
    v_and_b32 v101, 0xffff0000, v166
    v_lshlrev_b32 v102, 16, v167
    v_and_b32 v103, 0xffff0000, v167
    v_mfma_f32_16x16x32_bf16 v[72:75], v[192:195], v[244:247], v[72:75]
    s_add_u32 s49, s68, 32768
    buffer_store_dwordx4 v[128:131], v212, s[24:27], s49 offen sc1
    v_cvt_pk_bf16_f32 v164, v104, v105
    v_cvt_pk_bf16_f32 v165, v106, v107
    v_cvt_pk_bf16_f32 v166, v108, v109
    v_mfma_f32_16x16x32_bf16 v[76:79], v[196:199], v[244:247], v[76:79]
    v_cvt_pk_bf16_f32 v167, v110, v111
    v_lshlrev_b32 v104, 16, v168
    v_and_b32 v105, 0xffff0000, v168
    v_lshlrev_b32 v106, 16, v169
    ds_read_b128 v[244:247], v250 offset:25600
    s_waitcnt lgkmcnt(8)
    v_mfma_f32_16x16x32_bf16 v[80:83], v[180:183], v[200:203], v[80:83]
    v_and_b32 v107, 0xffff0000, v169
    v_lshlrev_b32 v108, 16, v170
    v_and_b32 v109, 0xffff0000, v170
    v_lshlrev_b32 v110, 16, v171
    v_mfma_f32_16x16x32_bf16 v[84:87], v[184:187], v[200:203], v[84:87]
    v_and_b32 v111, 0xffff0000, v171
    v_cvt_pk_bf16_f32 v168, v112, v113
    v_cvt_pk_bf16_f32 v169, v114, v115
    v_mfma_f32_16x16x32_bf16 v[88:91], v[188:191], v[200:203], v[88:91]
    v_cvt_pk_bf16_f32 v170, v116, v117
    v_cvt_pk_bf16_f32 v171, v118, v119
    v_lshlrev_b32 v112, 16, v172
    v_and_b32 v113, 0xffff0000, v172
    v_mfma_f32_16x16x32_bf16 v[92:95], v[192:195], v[200:203], v[92:95]
    v_lshlrev_b32 v114, 16, v173
    v_and_b32 v115, 0xffff0000, v173
    v_lshlrev_b32 v116, 16, v174
    v_and_b32 v117, 0xffff0000, v174
    v_mfma_f32_16x16x32_bf16 v[96:99], v[196:199], v[200:203], v[96:99]
    s_add_u32 s49, s68, 40960
    buffer_store_dwordx4 v[132:135], v212, s[24:27], s49 offen sc1
    v_lshlrev_b32 v118, 16, v175
    v_and_b32 v119, 0xffff0000, v175
    ds_read_b128 v[200:203], v250 offset:26624
    s_waitcnt lgkmcnt(3)
    v_mfma_f32_16x16x32_bf16 v[100:103], v[180:183], v[204:207], v[100:103]
    v_mfma_f32_16x16x32_bf16 v[104:107], v[184:187], v[204:207], v[104:107]
    v_mfma_f32_16x16x32_bf16 v[108:111], v[188:191], v[204:207], v[108:111]
    v_mfma_f32_16x16x32_bf16 v[112:115], v[192:195], v[204:207], v[112:115]
    v_mfma_f32_16x16x32_bf16 v[116:119], v[196:199], v[204:207], v[116:119]
    s_barrier
    ds_read_b128 v[204:207], v250 offset:27648
    s_waitcnt lgkmcnt(3)
    v_mfma_f32_16x16x32_bf16 v[0:3], v[224:227], v[208:211], v[0:3]
    ds_read_b64_tr_b16 v[180:181], v251 offset:0
    v_mfma_f32_16x16x32_bf16 v[4:7], v[228:231], v[208:211], v[4:7]
    ds_read_b64_tr_b16 v[182:183], v251 offset:2560
    v_mfma_f32_16x16x32_bf16 v[8:11], v[232:235], v[208:211], v[8:11]
    ds_read_b64_tr_b16 v[184:185], v251 offset:32
    v_mfma_f32_16x16x32_bf16 v[12:15], v[236:239], v[208:211], v[12:15]
    ds_read_b64_tr_b16 v[186:187], v251 offset:2592
    v_mfma_f32_16x16x32_bf16 v[16:19], v[240:243], v[208:211], v[16:19]
    ds_read_b64_tr_b16 v[188:189], v251 offset:64
    ds_read_b128 v[208:211], v250 offset:28672
    s_waitcnt lgkmcnt(8)
    v_mfma_f32_16x16x32_bf16 v[20:23], v[224:227], v[244:247], v[20:23]
    ds_read_b64_tr_b16 v[190:191], v251 offset:2624
    v_mfma_f32_16x16x32_bf16 v[24:27], v[228:231], v[244:247], v[24:27]
    ds_read_b64_tr_b16 v[192:193], v251 offset:96
    v_mfma_f32_16x16x32_bf16 v[28:31], v[232:235], v[244:247], v[28:31]
    ds_read_b64_tr_b16 v[194:195], v251 offset:2656
    v_mfma_f32_16x16x32_bf16 v[32:35], v[236:239], v[244:247], v[32:35]
    ds_read_b64_tr_b16 v[196:197], v251 offset:128
    v_mfma_f32_16x16x32_bf16 v[36:39], v[240:243], v[244:247], v[36:39]
    ds_read_b64_tr_b16 v[198:199], v251 offset:2688
    ds_read_b128 v[244:247], v250 offset:29696
    s_waitcnt lgkmcnt(13)
    v_mfma_f32_16x16x32_bf16 v[40:43], v[224:227], v[200:203], v[40:43]
    v_mfma_f32_16x16x32_bf16 v[44:47], v[228:231], v[200:203], v[44:47]
    v_mfma_f32_16x16x32_bf16 v[48:51], v[232:235], v[200:203], v[48:51]
    s_add_u32 s49, s68, 49152
    buffer_store_dwordx4 v[136:139], v212, s[24:27], s49 offen sc1
    v_mfma_f32_16x16x32_bf16 v[52:55], v[236:239], v[200:203], v[52:55]
    v_mfma_f32_16x16x32_bf16 v[56:59], v[240:243], v[200:203], v[56:59]
    ds_read_b128 v[200:203], v250 offset:30720
    s_waitcnt lgkmcnt(13)
    v_mfma_f32_16x16x32_bf16 v[60:63], v[224:227], v[204:207], v[60:63]
    v_mfma_f32_16x16x32_bf16 v[64:67], v[228:231], v[204:207], v[64:67]
    v_mfma_f32_16x16x32_bf16 v[68:71], v[232:235], v[204:207], v[68:71]
    v_mfma_f32_16x16x32_bf16 v[72:75], v[236:239], v[204:207], v[72:75]
    s_add_u32 s49, s68, 57344
    buffer_store_dwordx4 v[140:143], v212, s[24:27], s49 offen sc1
    v_mfma_f32_16x16x32_bf16 v[76:79], v[240:243], v[204:207], v[76:79]
    ds_read_b128 v[204:207], v250 offset:31744
    s_waitcnt lgkmcnt(8)
    v_mfma_f32_16x16x32_bf16 v[80:83], v[224:227], v[208:211], v[80:83]
    v_mfma_f32_16x16x32_bf16 v[84:87], v[228:231], v[208:211], v[84:87]
    v_mfma_f32_16x16x32_bf16 v[88:91], v[232:235], v[208:211], v[88:91]
    v_mfma_f32_16x16x32_bf16 v[92:95], v[236:239], v[208:211], v[92:95]
    v_mfma_f32_16x16x32_bf16 v[96:99], v[240:243], v[208:211], v[96:99]
    s_add_u32 s49, s68, 65536
    buffer_store_dwordx4 v[144:147], v212, s[24:27], s49 offen sc1
    ds_read_b128 v[208:211], v250 offset:32768
    s_waitcnt lgkmcnt(3)
    v_mfma_f32_16x16x32_bf16 v[100:103], v[224:227], v[244:247], v[100:103]
    v_mfma_f32_16x16x32_bf16 v[104:107], v[228:231], v[244:247], v[104:107]
    v_mfma_f32_16x16x32_bf16 v[108:111], v[232:235], v[244:247], v[108:111]
    v_mfma_f32_16x16x32_bf16 v[112:115], v[236:239], v[244:247], v[112:115]
    v_mfma_f32_16x16x32_bf16 v[116:119], v[240:243], v[244:247], v[116:119]
    s_barrier
    ds_read_b128 v[244:247], v250 offset:33792
    s_waitcnt lgkmcnt(3)
    v_mfma_f32_16x16x32_bf16 v[0:3], v[180:183], v[200:203], v[0:3]
    ds_read_b64_tr_b16 v[224:225], v249 offset:0
    v_mfma_f32_16x16x32_bf16 v[4:7], v[184:187], v[200:203], v[4:7]
    ds_read_b64_tr_b16 v[226:227], v249 offset:2560
    v_mfma_f32_16x16x32_bf16 v[8:11], v[188:191], v[200:203], v[8:11]
    ds_read_b64_tr_b16 v[228:229], v249 offset:32
    v_mfma_f32_16x16x32_bf16 v[12:15], v[192:195], v[200:203], v[12:15]
    ds_read_b64_tr_b16 v[230:231], v249 offset:2592
    v_mfma_f32_16x16x32_bf16 v[16:19], v[196:199], v[200:203], v[16:19]
    ds_read_b64_tr_b16 v[232:233], v249 offset:64
    ds_read_b128 v[200:203], v250 offset:34816
    s_waitcnt lgkmcnt(8)
    v_mfma_f32_16x16x32_bf16 v[20:23], v[180:183], v[204:207], v[20:23]
    ds_read_b64_tr_b16 v[234:235], v249 offset:2624
    v_mfma_f32_16x16x32_bf16 v[24:27], v[184:187], v[204:207], v[24:27]
    ds_read_b64_tr_b16 v[236:237], v249 offset:96
    v_mfma_f32_16x16x32_bf16 v[28:31], v[188:191], v[204:207], v[28:31]
    ds_read_b64_tr_b16 v[238:239], v249 offset:2656
    v_mfma_f32_16x16x32_bf16 v[32:35], v[192:195], v[204:207], v[32:35]
    ds_read_b64_tr_b16 v[240:241], v249 offset:128
    v_mfma_f32_16x16x32_bf16 v[36:39], v[196:199], v[204:207], v[36:39]
    ds_read_b64_tr_b16 v[242:243], v249 offset:2688
    ds_read_b128 v[204:207], v250 offset:35840
    s_waitcnt lgkmcnt(13)
    v_mfma_f32_16x16x32_bf16 v[40:43], v[180:183], v[208:211], v[40:43]
    v_mfma_f32_16x16x32_bf16 v[44:47], v[184:187], v[208:211], v[44:47]
    v_mfma_f32_16x16x32_bf16 v[48:51], v[188:191], v[208:211], v[48:51]
    s_add_u32 s49, s68, 73728
    buffer_store_dwordx4 v[148:151], v212, s[24:27], s49 offen sc1
    v_mfma_f32_16x16x32_bf16 v[52:55], v[192:195], v[208:211], v[52:55]
    v_mfma_f32_16x16x32_bf16 v[56:59], v[196:199], v[208:211], v[56:59]
    ds_read_b128 v[208:211], v248 offset:0
    s_waitcnt lgkmcnt(13)
    v_mfma_f32_16x16x32_bf16 v[60:63], v[180:183], v[244:247], v[60:63]
    v_mfma_f32_16x16x32_bf16 v[64:67], v[184:187], v[244:247], v[64:67]
    v_mfma_f32_16x16x32_bf16 v[68:71], v[188:191], v[244:247], v[68:71]
    v_mfma_f32_16x16x32_bf16 v[72:75], v[192:195], v[244:247], v[72:75]
    s_add_u32 s49, s68, 81920
    buffer_store_dwordx4 v[152:155], v212, s[24:27], s49 offen sc1
    v_mfma_f32_16x16x32_bf16 v[76:79], v[196:199], v[244:247], v[76:79]
    ds_read_b128 v[244:247], v248 offset:1024
    s_waitcnt lgkmcnt(8)
    v_mfma_f32_16x16x32_bf16 v[80:83], v[180:183], v[200:203], v[80:83]
    v_mfma_f32_16x16x32_bf16 v[84:87], v[184:187], v[200:203], v[84:87]
    v_mfma_f32_16x16x32_bf16 v[88:91], v[188:191], v[200:203], v[88:91]
    v_mfma_f32_16x16x32_bf16 v[92:95], v[192:195], v[200:203], v[92:95]
    v_mfma_f32_16x16x32_bf16 v[96:99], v[196:199], v[200:203], v[96:99]
    s_add_u32 s49, s68, 90112
    buffer_store_dwordx4 v[156:159], v212, s[24:27], s49 offen sc1
    ds_read_b128 v[200:203], v248 offset:2048
    s_waitcnt lgkmcnt(3)
    v_mfma_f32_16x16x32_bf16 v[100:103], v[180:183], v[204:207], v[100:103]
    v_mfma_f32_16x16x32_bf16 v[104:107], v[184:187], v[204:207], v[104:107]
    v_mfma_f32_16x16x32_bf16 v[108:111], v[188:191], v[204:207], v[108:111]
    v_mfma_f32_16x16x32_bf16 v[112:115], v[192:195], v[204:207], v[112:115]
    v_mfma_f32_16x16x32_bf16 v[116:119], v[196:199], v[204:207], v[116:119]
    s_barrier
    ds_read_b128 v[204:207], v248 offset:3072
    s_waitcnt lgkmcnt(3)
    v_mfma_f32_16x16x32_bf16 v[0:3], v[224:227], v[208:211], v[0:3]
    ds_read_b64_tr_b16 v[180:181], v249 offset:20480
    v_mfma_f32_16x16x32_bf16 v[4:7], v[228:231], v[208:211], v[4:7]
    ds_read_b64_tr_b16 v[182:183], v249 offset:23040
    v_mfma_f32_16x16x32_bf16 v[8:11], v[232:235], v[208:211], v[8:11]
    ds_read_b64_tr_b16 v[184:185], v249 offset:20512
    v_mfma_f32_16x16x32_bf16 v[12:15], v[236:239], v[208:211], v[12:15]
    ds_read_b64_tr_b16 v[186:187], v249 offset:23072
    v_mfma_f32_16x16x32_bf16 v[16:19], v[240:243], v[208:211], v[16:19]
    ds_read_b64_tr_b16 v[188:189], v249 offset:20544
    ds_read_b128 v[208:211], v248 offset:4096
    s_waitcnt lgkmcnt(8)
    v_mfma_f32_16x16x32_bf16 v[20:23], v[224:227], v[244:247], v[20:23]
    ds_read_b64_tr_b16 v[190:191], v249 offset:23104
    v_mfma_f32_16x16x32_bf16 v[24:27], v[228:231], v[244:247], v[24:27]
    ds_read_b64_tr_b16 v[192:193], v249 offset:20576
    v_mfma_f32_16x16x32_bf16 v[28:31], v[232:235], v[244:247], v[28:31]
    ds_read_b64_tr_b16 v[194:195], v249 offset:23136
    v_mfma_f32_16x16x32_bf16 v[32:35], v[236:239], v[244:247], v[32:35]
    ds_read_b64_tr_b16 v[196:197], v249 offset:20608
    v_mfma_f32_16x16x32_bf16 v[36:39], v[240:243], v[244:247], v[36:39]
    ds_read_b64_tr_b16 v[198:199], v249 offset:23168
    ds_read_b128 v[244:247], v248 offset:5120
    s_waitcnt lgkmcnt(13)
    v_mfma_f32_16x16x32_bf16 v[40:43], v[224:227], v[200:203], v[40:43]
    v_mfma_f32_16x16x32_bf16 v[44:47], v[228:231], v[200:203], v[44:47]
    v_mfma_f32_16x16x32_bf16 v[48:51], v[232:235], v[200:203], v[48:51]
    s_add_u32 s49, s68, 98304
    buffer_store_dwordx4 v[160:163], v212, s[24:27], s49 offen sc1
    v_mfma_f32_16x16x32_bf16 v[52:55], v[236:239], v[200:203], v[52:55]
    v_mfma_f32_16x16x32_bf16 v[56:59], v[240:243], v[200:203], v[56:59]
    ds_read_b128 v[200:203], v248 offset:6144
    s_waitcnt lgkmcnt(13)
    v_mfma_f32_16x16x32_bf16 v[60:63], v[224:227], v[204:207], v[60:63]
    v_mfma_f32_16x16x32_bf16 v[64:67], v[228:231], v[204:207], v[64:67]
    v_mfma_f32_16x16x32_bf16 v[68:71], v[232:235], v[204:207], v[68:71]
    v_mfma_f32_16x16x32_bf16 v[72:75], v[236:239], v[204:207], v[72:75]
    s_add_u32 s49, s68, 106496
    buffer_store_dwordx4 v[164:167], v212, s[24:27], s49 offen sc1
    v_mfma_f32_16x16x32_bf16 v[76:79], v[240:243], v[204:207], v[76:79]
    ds_read_b128 v[204:207], v248 offset:7168
    s_waitcnt lgkmcnt(8)
    v_mfma_f32_16x16x32_bf16 v[80:83], v[224:227], v[208:211], v[80:83]
    v_mfma_f32_16x16x32_bf16 v[84:87], v[228:231], v[208:211], v[84:87]
    v_mfma_f32_16x16x32_bf16 v[88:91], v[232:235], v[208:211], v[88:91]
    v_mfma_f32_16x16x32_bf16 v[92:95], v[236:239], v[208:211], v[92:95]
    v_mfma_f32_16x16x32_bf16 v[96:99], v[240:243], v[208:211], v[96:99]
    s_add_u32 s49, s68, 114688
    buffer_store_dwordx4 v[168:171], v212, s[24:27], s49 offen sc1
    ds_read_b128 v[208:211], v248 offset:8192
    s_waitcnt lgkmcnt(3)
    v_mfma_f32_16x16x32_bf16 v[100:103], v[224:227], v[244:247], v[100:103]
    v_mfma_f32_16x16x32_bf16 v[104:107], v[228:231], v[244:247], v[104:107]
    v_mfma_f32_16x16x32_bf16 v[108:111], v[232:235], v[244:247], v[108:111]
    v_mfma_f32_16x16x32_bf16 v[112:115], v[236:239], v[244:247], v[112:115]
    v_mfma_f32_16x16x32_bf16 v[116:119], v[240:243], v[244:247], v[116:119]
    s_barrier
    ds_read_b128 v[244:247], v248 offset:9216
    s_waitcnt lgkmcnt(3)
    v_mfma_f32_16x16x32_bf16 v[0:3], v[180:183], v[200:203], v[0:3]
    ds_read_b64_tr_b16 v[224:225], v251 offset:0
    v_mfma_f32_16x16x32_bf16 v[4:7], v[184:187], v[200:203], v[4:7]
    ds_read_b64_tr_b16 v[226:227], v251 offset:2560
    v_mfma_f32_16x16x32_bf16 v[8:11], v[188:191], v[200:203], v[8:11]
    ds_read_b64_tr_b16 v[228:229], v251 offset:32
    v_mfma_f32_16x16x32_bf16 v[12:15], v[192:195], v[200:203], v[12:15]
    ds_read_b64_tr_b16 v[230:231], v251 offset:2592
    v_mfma_f32_16x16x32_bf16 v[16:19], v[196:199], v[200:203], v[16:19]
    ds_read_b64_tr_b16 v[232:233], v251 offset:64
    ds_read_b128 v[200:203], v248 offset:10240
    s_waitcnt lgkmcnt(8)
    v_mfma_f32_16x16x32_bf16 v[20:23], v[180:183], v[204:207], v[20:23]
    ds_read_b64_tr_b16 v[234:235], v251 offset:2624
    v_mfma_f32_16x16x32_bf16 v[24:27], v[184:187], v[204:207], v[24:27]
    ds_read_b64_tr_b16 v[236:237], v251 offset:96
    v_mfma_f32_16x16x32_bf16 v[28:31], v[188:191], v[204:207], v[28:31]
    ds_read_b64_tr_b16 v[238:239], v251 offset:2656
    v_mfma_f32_16x16x32_bf16 v[32:35], v[192:195], v[204:207], v[32:35]
    ds_read_b64_tr_b16 v[240:241], v251 offset:128
    v_mfma_f32_16x16x32_bf16 v[36:39], v[196:199], v[204:207], v[36:39]
    ds_read_b64_tr_b16 v[242:243], v251 offset:2688
    ds_read_b128 v[204:207], v248 offset:11264
    s_waitcnt lgkmcnt(13)
    v_mfma_f32_16x16x32_bf16 v[40:43], v[180:183], v[208:211], v[40:43]
    v_mfma_f32_16x16x32_bf16 v[44:47], v[184:187], v[208:211], v[44:47]
    v_mfma_f32_16x16x32_bf16 v[48:51], v[188:191], v[208:211], v[48:51]
    v_mfma_f32_16x16x32_bf16 v[52:55], v[192:195], v[208:211], v[52:55]
    v_mfma_f32_16x16x32_bf16 v[56:59], v[196:199], v[208:211], v[56:59]
    ds_read_b128 v[208:211], v248 offset:12288
    s_waitcnt lgkmcnt(13)
    v_mfma_f32_16x16x32_bf16 v[60:63], v[180:183], v[244:247], v[60:63]
    v_mfma_f32_16x16x32_bf16 v[64:67], v[184:187], v[244:247], v[64:67]
    v_mfma_f32_16x16x32_bf16 v[68:71], v[188:191], v[244:247], v[68:71]
    v_mfma_f32_16x16x32_bf16 v[72:75], v[192:195], v[244:247], v[72:75]
    v_mfma_f32_16x16x32_bf16 v[76:79], v[196:199], v[244:247], v[76:79]
    ds_read_b128 v[244:247], v248 offset:13312
    s_waitcnt lgkmcnt(8)
    v_mfma_f32_16x16x32_bf16 v[80:83], v[180:183], v[200:203], v[80:83]
    v_mfma_f32_16x16x32_bf16 v[84:87], v[184:187], v[200:203], v[84:87]
    v_mfma_f32_16x16x32_bf16 v[88:91], v[188:191], v[200:203], v[88:91]
    v_mfma_f32_16x16x32_bf16 v[92:95], v[192:195], v[200:203], v[92:95]
    v_mfma_f32_16x16x32_bf16 v[96:99], v[196:199], v[200:203], v[96:99]
    ds_read_b128 v[200:203], v248 offset:14336
    s_waitcnt lgkmcnt(3)
    v_mfma_f32_16x16x32_bf16 v[100:103], v[180:183], v[204:207], v[100:103]
    v_mfma_f32_16x16x32_bf16 v[104:107], v[184:187], v[204:207], v[104:107]
    v_mfma_f32_16x16x32_bf16 v[108:111], v[188:191], v[204:207], v[108:111]
    v_mfma_f32_16x16x32_bf16 v[112:115], v[192:195], v[204:207], v[112:115]
    v_mfma_f32_16x16x32_bf16 v[116:119], v[196:199], v[204:207], v[116:119]
    s_barrier
    ds_read_b128 v[204:207], v248 offset:15360
    s_waitcnt lgkmcnt(3)
    v_mfma_f32_16x16x32_bf16 v[0:3], v[224:227], v[208:211], v[0:3]
    ds_read_b64_tr_b16 v[180:181], v249 offset:0
    v_mfma_f32_16x16x32_bf16 v[4:7], v[228:231], v[208:211], v[4:7]
    ds_read_b64_tr_b16 v[182:183], v249 offset:2560
    v_mfma_f32_16x16x32_bf16 v[8:11], v[232:235], v[208:211], v[8:11]
    ds_read_b64_tr_b16 v[184:185], v249 offset:32
    v_mfma_f32_16x16x32_bf16 v[12:15], v[236:239], v[208:211], v[12:15]
    ds_read_b64_tr_b16 v[186:187], v249 offset:2592
    v_mfma_f32_16x16x32_bf16 v[16:19], v[240:243], v[208:211], v[16:19]
    ds_read_b64_tr_b16 v[188:189], v249 offset:64
    ds_read_b128 v[208:211], v248 offset:16384
    s_waitcnt lgkmcnt(8)
    v_mfma_f32_16x16x32_bf16 v[20:23], v[224:227], v[244:247], v[20:23]
    ds_read_b64_tr_b16 v[190:191], v249 offset:2624
    v_mfma_f32_16x16x32_bf16 v[24:27], v[228:231], v[244:247], v[24:27]
    ds_read_b64_tr_b16 v[192:193], v249 offset:96
    v_mfma_f32_16x16x32_bf16 v[28:31], v[232:235], v[244:247], v[28:31]
    ds_read_b64_tr_b16 v[194:195], v249 offset:2656
    v_mfma_f32_16x16x32_bf16 v[32:35], v[236:239], v[244:247], v[32:35]
    ds_read_b64_tr_b16 v[196:197], v249 offset:128
    v_mfma_f32_16x16x32_bf16 v[36:39], v[240:243], v[244:247], v[36:39]
    ds_read_b64_tr_b16 v[198:199], v249 offset:2688
    ds_read_b128 v[244:247], v248 offset:17408
    s_waitcnt lgkmcnt(13)
    v_mfma_f32_16x16x32_bf16 v[40:43], v[224:227], v[200:203], v[40:43]
    v_mfma_f32_16x16x32_bf16 v[44:47], v[228:231], v[200:203], v[44:47]
    v_mfma_f32_16x16x32_bf16 v[48:51], v[232:235], v[200:203], v[48:51]
    v_mfma_f32_16x16x32_bf16 v[52:55], v[236:239], v[200:203], v[52:55]
    v_mfma_f32_16x16x32_bf16 v[56:59], v[240:243], v[200:203], v[56:59]
    ds_read_b128 v[200:203], v248 offset:18432
    s_waitcnt lgkmcnt(13)
    v_mfma_f32_16x16x32_bf16 v[60:63], v[224:227], v[204:207], v[60:63]
    v_mfma_f32_16x16x32_bf16 v[64:67], v[228:231], v[204:207], v[64:67]
    v_mfma_f32_16x16x32_bf16 v[68:71], v[232:235], v[204:207], v[68:71]
    v_mfma_f32_16x16x32_bf16 v[72:75], v[236:239], v[204:207], v[72:75]
    v_mfma_f32_16x16x32_bf16 v[76:79], v[240:243], v[204:207], v[76:79]
    ds_read_b128 v[204:207], v248 offset:19456
    s_waitcnt lgkmcnt(8)
    v_mfma_f32_16x16x32_bf16 v[80:83], v[224:227], v[208:211], v[80:83]
    v_mfma_f32_16x16x32_bf16 v[84:87], v[228:231], v[208:211], v[84:87]
    v_mfma_f32_16x16x32_bf16 v[88:91], v[232:235], v[208:211], v[88:91]
    v_mfma_f32_16x16x32_bf16 v[92:95], v[236:239], v[208:211], v[92:95]
    v_mfma_f32_16x16x32_bf16 v[96:99], v[240:243], v[208:211], v[96:99]
    ds_read_b128 v[208:211], v248 offset:20480
    s_waitcnt lgkmcnt(3)
    v_mfma_f32_16x16x32_bf16 v[100:103], v[224:227], v[244:247], v[100:103]
    v_mfma_f32_16x16x32_bf16 v[104:107], v[228:231], v[244:247], v[104:107]
    v_mfma_f32_16x16x32_bf16 v[108:111], v[232:235], v[244:247], v[108:111]
    v_mfma_f32_16x16x32_bf16 v[112:115], v[236:239], v[244:247], v[112:115]
    v_mfma_f32_16x16x32_bf16 v[116:119], v[240:243], v[244:247], v[116:119]
    s_barrier
    ds_read_b128 v[244:247], v248 offset:21504
    s_waitcnt lgkmcnt(3)
    v_mfma_f32_16x16x32_bf16 v[0:3], v[180:183], v[200:203], v[0:3]
    ds_read_b64_tr_b16 v[224:225], v251 offset:20480
    v_mfma_f32_16x16x32_bf16 v[4:7], v[184:187], v[200:203], v[4:7]
    ds_read_b64_tr_b16 v[226:227], v251 offset:23040
    v_mfma_f32_16x16x32_bf16 v[8:11], v[188:191], v[200:203], v[8:11]
    ds_read_b64_tr_b16 v[228:229], v251 offset:20512
    v_mfma_f32_16x16x32_bf16 v[12:15], v[192:195], v[200:203], v[12:15]
    ds_read_b64_tr_b16 v[230:231], v251 offset:23072
    v_mfma_f32_16x16x32_bf16 v[16:19], v[196:199], v[200:203], v[16:19]
    ds_read_b64_tr_b16 v[232:233], v251 offset:20544
    ds_read_b128 v[200:203], v248 offset:22528
    s_waitcnt lgkmcnt(8)
    v_mfma_f32_16x16x32_bf16 v[20:23], v[180:183], v[204:207], v[20:23]
    ds_read_b64_tr_b16 v[234:235], v251 offset:23104
    v_mfma_f32_16x16x32_bf16 v[24:27], v[184:187], v[204:207], v[24:27]
    ds_read_b64_tr_b16 v[236:237], v251 offset:20576
    v_mfma_f32_16x16x32_bf16 v[28:31], v[188:191], v[204:207], v[28:31]
    ds_read_b64_tr_b16 v[238:239], v251 offset:23136
    v_mfma_f32_16x16x32_bf16 v[32:35], v[192:195], v[204:207], v[32:35]
    ds_read_b64_tr_b16 v[240:241], v251 offset:20608
    v_mfma_f32_16x16x32_bf16 v[36:39], v[196:199], v[204:207], v[36:39]
    ds_read_b64_tr_b16 v[242:243], v251 offset:23168
    ds_read_b128 v[204:207], v248 offset:23552
    s_waitcnt lgkmcnt(13)
    v_mfma_f32_16x16x32_bf16 v[40:43], v[180:183], v[208:211], v[40:43]
    v_mfma_f32_16x16x32_bf16 v[44:47], v[184:187], v[208:211], v[44:47]
    v_mfma_f32_16x16x32_bf16 v[48:51], v[188:191], v[208:211], v[48:51]
    v_mfma_f32_16x16x32_bf16 v[52:55], v[192:195], v[208:211], v[52:55]
    v_mfma_f32_16x16x32_bf16 v[56:59], v[196:199], v[208:211], v[56:59]
    ds_read_b128 v[208:211], v248 offset:24576
    s_waitcnt lgkmcnt(13)
    v_mfma_f32_16x16x32_bf16 v[60:63], v[180:183], v[244:247], v[60:63]
    v_mfma_f32_16x16x32_bf16 v[64:67], v[184:187], v[244:247], v[64:67]
    v_mfma_f32_16x16x32_bf16 v[68:71], v[188:191], v[244:247], v[68:71]
    v_mfma_f32_16x16x32_bf16 v[72:75], v[192:195], v[244:247], v[72:75]
    v_mfma_f32_16x16x32_bf16 v[76:79], v[196:199], v[244:247], v[76:79]
    ds_read_b128 v[244:247], v248 offset:25600
    s_waitcnt lgkmcnt(8)
    v_mfma_f32_16x16x32_bf16 v[80:83], v[180:183], v[200:203], v[80:83]
    v_mfma_f32_16x16x32_bf16 v[84:87], v[184:187], v[200:203], v[84:87]
    v_mfma_f32_16x16x32_bf16 v[88:91], v[188:191], v[200:203], v[88:91]
    v_mfma_f32_16x16x32_bf16 v[92:95], v[192:195], v[200:203], v[92:95]
    v_mfma_f32_16x16x32_bf16 v[96:99], v[196:199], v[200:203], v[96:99]
    ds_read_b128 v[200:203], v248 offset:26624
    s_waitcnt lgkmcnt(3)
    v_mfma_f32_16x16x32_bf16 v[100:103], v[180:183], v[204:207], v[100:103]
    v_mfma_f32_16x16x32_bf16 v[104:107], v[184:187], v[204:207], v[104:107]
    v_mfma_f32_16x16x32_bf16 v[108:111], v[188:191], v[204:207], v[108:111]
    v_mfma_f32_16x16x32_bf16 v[112:115], v[192:195], v[204:207], v[112:115]
    v_mfma_f32_16x16x32_bf16 v[116:119], v[196:199], v[204:207], v[116:119]
    s_barrier
    ds_read_b128 v[204:207], v248 offset:27648
    s_waitcnt lgkmcnt(3)
    v_mfma_f32_16x16x32_bf16 v[0:3], v[224:227], v[208:211], v[0:3]
    ds_read_b64_tr_b16 v[180:181], v251 offset:40960
    v_mfma_f32_16x16x32_bf16 v[4:7], v[228:231], v[208:211], v[4:7]
    ds_read_b64_tr_b16 v[182:183], v251 offset:43520
    v_mfma_f32_16x16x32_bf16 v[8:11], v[232:235], v[208:211], v[8:11]
    ds_read_b64_tr_b16 v[184:185], v251 offset:40992
    v_mfma_f32_16x16x32_bf16 v[12:15], v[236:239], v[208:211], v[12:15]
    ds_read_b64_tr_b16 v[186:187], v251 offset:43552
    v_mfma_f32_16x16x32_bf16 v[16:19], v[240:243], v[208:211], v[16:19]
    ds_read_b64_tr_b16 v[188:189], v251 offset:41024
    ds_read_b128 v[208:211], v248 offset:28672
    s_waitcnt lgkmcnt(8)
    v_mfma_f32_16x16x32_bf16 v[20:23], v[224:227], v[244:247], v[20:23]
    ds_read_b64_tr_b16 v[190:191], v251 offset:43584
    v_mfma_f32_16x16x32_bf16 v[24:27], v[228:231], v[244:247], v[24:27]
    ds_read_b64_tr_b16 v[192:193], v251 offset:41056
    v_mfma_f32_16x16x32_bf16 v[28:31], v[232:235], v[244:247], v[28:31]
    ds_read_b64_tr_b16 v[194:195], v251 offset:43616
    v_mfma_f32_16x16x32_bf16 v[32:35], v[236:239], v[244:247], v[32:35]
    ds_read_b64_tr_b16 v[196:197], v251 offset:41088
    v_mfma_f32_16x16x32_bf16 v[36:39], v[240:243], v[244:247], v[36:39]
    ds_read_b64_tr_b16 v[198:199], v251 offset:43648
    ds_read_b128 v[244:247], v248 offset:29696
    s_waitcnt lgkmcnt(13)
    v_mfma_f32_16x16x32_bf16 v[40:43], v[224:227], v[200:203], v[40:43]
    v_mfma_f32_16x16x32_bf16 v[44:47], v[228:231], v[200:203], v[44:47]
    v_mfma_f32_16x16x32_bf16 v[48:51], v[232:235], v[200:203], v[48:51]
    v_mfma_f32_16x16x32_bf16 v[52:55], v[236:239], v[200:203], v[52:55]
    v_mfma_f32_16x16x32_bf16 v[56:59], v[240:243], v[200:203], v[56:59]
    ds_read_b128 v[200:203], v248 offset:30720
    s_waitcnt lgkmcnt(13)
    v_mfma_f32_16x16x32_bf16 v[60:63], v[224:227], v[204:207], v[60:63]
    v_mfma_f32_16x16x32_bf16 v[64:67], v[228:231], v[204:207], v[64:67]
    v_mfma_f32_16x16x32_bf16 v[68:71], v[232:235], v[204:207], v[68:71]
    v_mfma_f32_16x16x32_bf16 v[72:75], v[236:239], v[204:207], v[72:75]
    v_mfma_f32_16x16x32_bf16 v[76:79], v[240:243], v[204:207], v[76:79]
    ds_read_b128 v[204:207], v248 offset:31744
    s_waitcnt lgkmcnt(8)
    v_mfma_f32_16x16x32_bf16 v[80:83], v[224:227], v[208:211], v[80:83]
    v_mfma_f32_16x16x32_bf16 v[84:87], v[228:231], v[208:211], v[84:87]
    v_mfma_f32_16x16x32_bf16 v[88:91], v[232:235], v[208:211], v[88:91]
    v_mfma_f32_16x16x32_bf16 v[92:95], v[236:239], v[208:211], v[92:95]
    v_mfma_f32_16x16x32_bf16 v[96:99], v[240:243], v[208:211], v[96:99]
    ds_read_b128 v[208:211], v248 offset:32768
    s_waitcnt lgkmcnt(3)
    v_mfma_f32_16x16x32_bf16 v[100:103], v[224:227], v[244:247], v[100:103]
    v_mfma_f32_16x16x32_bf16 v[104:107], v[228:231], v[244:247], v[104:107]
    v_mfma_f32_16x16x32_bf16 v[108:111], v[232:235], v[244:247], v[108:111]
    v_mfma_f32_16x16x32_bf16 v[112:115], v[236:239], v[244:247], v[112:115]
    v_mfma_f32_16x16x32_bf16 v[116:119], v[240:243], v[244:247], v[116:119]
    ds_read_b128 v[244:247], v248 offset:33792
    s_waitcnt lgkmcnt(3)
    v_mfma_f32_16x16x32_bf16 v[0:3], v[180:183], v[200:203], v[0:3]
    v_mfma_f32_16x16x32_bf16 v[4:7], v[184:187], v[200:203], v[4:7]
    v_mfma_f32_16x16x32_bf16 v[8:11], v[188:191], v[200:203], v[8:11]
    v_mfma_f32_16x16x32_bf16 v[12:15], v[192:195], v[200:203], v[12:15]
    v_mfma_f32_16x16x32_bf16 v[16:19], v[196:199], v[200:203], v[16:19]
    ds_read_b128 v[200:203], v248 offset:34816
    s_waitcnt lgkmcnt(3)
    v_mfma_f32_16x16x32_bf16 v[20:23], v[180:183], v[204:207], v[20:23]
    v_mfma_f32_16x16x32_bf16 v[24:27], v[184:187], v[204:207], v[24:27]
    v_mfma_f32_16x16x32_bf16 v[28:31], v[188:191], v[204:207], v[28:31]
    v_cvt_pk_bf16_f32 v120, v0, v1
    v_cvt_pk_bf16_f32 v121, v2, v3
    v_cvt_pk_bf16_f32 v122, v4, v5
    v_cvt_pk_bf16_f32 v123, v6, v7
    s_add_u32 s49, s68, 557056
    buffer_store_dwordx4 v[120:123], v212, s[24:27], s49 offen sc1
    v_mfma_f32_16x16x32_bf16 v[32:35], v[192:195], v[204:207], v[32:35]
    v_mfma_f32_16x16x32_bf16 v[36:39], v[196:199], v[204:207], v[36:39]
    v_cvt_pk_bf16_f32 v124, v8, v9
    v_cvt_pk_bf16_f32 v125, v10, v11
    v_cvt_pk_bf16_f32 v126, v12, v13
    v_cvt_pk_bf16_f32 v127, v14, v15
    s_add_u32 s49, s68, 565248
    buffer_store_dwordx4 v[124:127], v212, s[24:27], s49 offen sc1
    ds_read_b128 v[204:207], v248 offset:35840
    s_waitcnt lgkmcnt(3)
    v_mfma_f32_16x16x32_bf16 v[40:43], v[180:183], v[208:211], v[40:43]
    v_mfma_f32_16x16x32_bf16 v[44:47], v[184:187], v[208:211], v[44:47]
    v_cvt_pk_bf16_f32 v128, v16, v17
    v_cvt_pk_bf16_f32 v129, v18, v19
    v_cvt_pk_bf16_f32 v130, v20, v21
    v_cvt_pk_bf16_f32 v131, v22, v23
    s_add_u32 s49, s68, 573440
    buffer_store_dwordx4 v[128:131], v212, s[24:27], s49 offen sc1
    v_mfma_f32_16x16x32_bf16 v[48:51], v[188:191], v[208:211], v[48:51]
    v_mfma_f32_16x16x32_bf16 v[52:55], v[192:195], v[208:211], v[52:55]
    v_cvt_pk_bf16_f32 v132, v24, v25
    v_cvt_pk_bf16_f32 v133, v26, v27
    v_cvt_pk_bf16_f32 v134, v28, v29
    v_cvt_pk_bf16_f32 v135, v30, v31
    s_add_u32 s49, s68, 581632
    buffer_store_dwordx4 v[132:135], v212, s[24:27], s49 offen sc1
    v_mfma_f32_16x16x32_bf16 v[56:59], v[196:199], v[208:211], v[56:59]
    s_waitcnt lgkmcnt(2)
    v_mfma_f32_16x16x32_bf16 v[60:63], v[180:183], v[244:247], v[60:63]
    v_cvt_pk_bf16_f32 v136, v32, v33
    v_cvt_pk_bf16_f32 v137, v34, v35
    v_cvt_pk_bf16_f32 v138, v36, v37
    v_cvt_pk_bf16_f32 v139, v38, v39
    s_add_u32 s49, s68, 589824
    buffer_store_dwordx4 v[136:139], v212, s[24:27], s49 offen sc1
    v_mfma_f32_16x16x32_bf16 v[64:67], v[184:187], v[244:247], v[64:67]
    v_mfma_f32_16x16x32_bf16 v[68:71], v[188:191], v[244:247], v[68:71]
    v_cvt_pk_bf16_f32 v140, v40, v41
    v_cvt_pk_bf16_f32 v141, v42, v43
    v_cvt_pk_bf16_f32 v142, v44, v45
    v_cvt_pk_bf16_f32 v143, v46, v47
    s_add_u32 s49, s68, 598016
    buffer_store_dwordx4 v[140:143], v212, s[24:27], s49 offen sc1
    v_mfma_f32_16x16x32_bf16 v[72:75], v[192:195], v[244:247], v[72:75]
    v_mfma_f32_16x16x32_bf16 v[76:79], v[196:199], v[244:247], v[76:79]
    v_cvt_pk_bf16_f32 v144, v48, v49
    v_cvt_pk_bf16_f32 v145, v50, v51
    v_cvt_pk_bf16_f32 v146, v52, v53
    v_cvt_pk_bf16_f32 v147, v54, v55
    s_add_u32 s49, s68, 606208
    buffer_store_dwordx4 v[144:147], v212, s[24:27], s49 offen sc1
    s_waitcnt lgkmcnt(1)
    v_mfma_f32_16x16x32_bf16 v[80:83], v[180:183], v[200:203], v[80:83]
    v_mfma_f32_16x16x32_bf16 v[84:87], v[184:187], v[200:203], v[84:87]
    v_cvt_pk_bf16_f32 v148, v56, v57
    v_cvt_pk_bf16_f32 v149, v58, v59
    v_cvt_pk_bf16_f32 v150, v60, v61
    v_cvt_pk_bf16_f32 v151, v62, v63
    s_add_u32 s49, s68, 614400
    buffer_store_dwordx4 v[148:151], v212, s[24:27], s49 offen sc1
    v_mfma_f32_16x16x32_bf16 v[88:91], v[188:191], v[200:203], v[88:91]
    v_mfma_f32_16x16x32_bf16 v[92:95], v[192:195], v[200:203], v[92:95]
    v_cvt_pk_bf16_f32 v152, v64, v65
    v_cvt_pk_bf16_f32 v153, v66, v67
    v_cvt_pk_bf16_f32 v154, v68, v69
    v_cvt_pk_bf16_f32 v155, v70, v71
    s_add_u32 s49, s68, 622592
    buffer_store_dwordx4 v[152:155], v212, s[24:27], s49 offen sc1
    v_mfma_f32_16x16x32_bf16 v[96:99], v[196:199], v[200:203], v[96:99]
    s_waitcnt lgkmcnt(0)
    v_mfma_f32_16x16x32_bf16 v[100:103], v[180:183], v[204:207], v[100:103]
    v_cvt_pk_bf16_f32 v156, v72, v73
    v_cvt_pk_bf16_f32 v157, v74, v75
    v_cvt_pk_bf16_f32 v158, v76, v77
    v_cvt_pk_bf16_f32 v159, v78, v79
    s_add_u32 s49, s68, 630784
    buffer_store_dwordx4 v[156:159], v212, s[24:27], s49 offen sc1
    v_mfma_f32_16x16x32_bf16 v[104:107], v[184:187], v[204:207], v[104:107]
    v_mfma_f32_16x16x32_bf16 v[108:111], v[188:191], v[204:207], v[108:111]
    v_cvt_pk_bf16_f32 v160, v80, v81
    v_cvt_pk_bf16_f32 v161, v82, v83
    v_cvt_pk_bf16_f32 v162, v84, v85
    v_cvt_pk_bf16_f32 v163, v86, v87
    s_add_u32 s49, s68, 638976
    buffer_store_dwordx4 v[160:163], v212, s[24:27], s49 offen sc1
    v_mfma_f32_16x16x32_bf16 v[112:115], v[192:195], v[204:207], v[112:115]
    v_mfma_f32_16x16x32_bf16 v[116:119], v[196:199], v[204:207], v[116:119]
    v_cvt_pk_bf16_f32 v164, v88, v89
    v_cvt_pk_bf16_f32 v165, v90, v91
    v_cvt_pk_bf16_f32 v166, v92, v93
    v_cvt_pk_bf16_f32 v167, v94, v95
    s_add_u32 s49, s68, 647168
    buffer_store_dwordx4 v[164:167], v212, s[24:27], s49 offen sc1
    v_cvt_pk_bf16_f32 v168, v96, v97
    v_cvt_pk_bf16_f32 v169, v98, v99
    v_cvt_pk_bf16_f32 v170, v100, v101
    v_cvt_pk_bf16_f32 v171, v102, v103
    s_add_u32 s49, s68, 655360
    buffer_store_dwordx4 v[168:171], v212, s[24:27], s49 offen sc1
    v_cvt_pk_bf16_f32 v172, v104, v105
    v_cvt_pk_bf16_f32 v173, v106, v107
    v_cvt_pk_bf16_f32 v174, v108, v109
    v_cvt_pk_bf16_f32 v175, v110, v111
    s_add_u32 s49, s68, 663552
    buffer_store_dwordx4 v[172:175], v212, s[24:27], s49 offen sc1
    v_cvt_pk_bf16_f32 v176, v112, v113
    v_cvt_pk_bf16_f32 v177, v114, v115
    v_cvt_pk_bf16_f32 v178, v116, v117
    v_cvt_pk_bf16_f32 v179, v118, v119
    s_add_u32 s49, s68, 671744
    buffer_store_dwordx4 v[176:179], v212, s[24:27], s49 offen sc1
    s_endpgm
P_sw7:
    v_mov_b32 v251, v252
    s_branch P_swr7
P_sw8:
    v_mov_b32 v251, v252
    s_branch P_swr8
P_sw9:
    v_mov_b32 v251, v252
    s_branch P_swr9
P_sw10:
    v_mov_b32 v251, v252
    s_branch P_swr10
P_sw11:
    v_mov_b32 v251, v252
    s_branch P_swr11
P_swap:
    s_setprio 0
    s_bitcmp1_b32 s53, 9
    s_cbranch_scc1 P_sw1st
    v_cvt_pk_bf16_f32 v220, v0, v1
    v_cvt_pk_bf16_f32 v221, v2, v3
    v_cvt_pk_bf16_f32 v222, v4, v5
    v_cvt_pk_bf16_f32 v223, v6, v7
    v_lshlrev_b32 v0, 16, v120
    v_and_b32 v1, 0xffff0000, v120
    v_lshlrev_b32 v2, 16, v121
    v_and_b32 v3, 0xffff0000, v121
    v_lshlrev_b32 v4, 16, v122
    v_and_b32 v5, 0xffff0000, v122
    v_lshlrev_b32 v6, 16, v123
    v_and_b32 v7, 0xffff0000, v123
    v_cvt_pk_bf16_f32 v120, v8, v9
    v_cvt_pk_bf16_f32 v121, v10, v11
    v_cvt_pk_bf16_f32 v122, v12, v13
    v_cvt_pk_bf16_f32 v123, v14, v15
    v_lshlrev_b32 v8, 16, v124
    v_and_b32 v9, 0xffff0000, v124
    v_lshlrev_b32 v10, 16, v125
    v_and_b32 v11, 0xffff0000, v125
    v_lshlrev_b32 v12, 16, v126
    v_and_b32 v13, 0xffff0000, v126
    v_lshlrev_b32 v14, 16, v127
    v_and_b32 v15, 0xffff0000, v127
    v_cvt_pk_bf16_f32 v124, v16, v17
    v_cvt_pk_bf16_f32 v125, v18, v19
    v_cvt_pk_bf16_f32 v126, v20, v21
    v_cvt_pk_bf16_f32 v127, v22, v23
    v_lshlrev_b32 v16, 16, v128
    v_and_b32 v17, 0xffff0000, v128
    v_lshlrev_b32 v18, 16, v129
    v_and_b32 v19, 0xffff0000, v129
    v_lshlrev_b32 v20, 16, v130
    v_and_b32 v21, 0xffff0000, v130
    v_lshlrev_b32 v22, 16, v131
    v_and_b32 v23, 0xffff0000, v131
    v_cvt_pk_bf16_f32 v128, v24, v25
    v_cvt_pk_bf16_f32 v129, v26, v27
    v_cvt_pk_bf16_f32 v130, v28, v29
    v_cvt_pk_bf16_f32 v131, v30, v31
    v_lshlrev_b32 v24, 16, v132
    v_and_b32 v25, 0xffff0000, v132
    v_lshlrev_b32 v26, 16, v133
    v_and_b32 v27, 0xffff0000, v133
    v_lshlrev_b32 v28, 16, v134
    v_and_b32 v29, 0xffff0000, v134
    v_lshlrev_b32 v30, 16, v135
    v_and_b32 v31, 0xffff0000, v135
    v_cvt_pk_bf16_f32 v132, v32, v33
    v_cvt_pk_bf16_f32 v133, v34, v35
    v_cvt_pk_bf16_f32 v134, v36, v37
    v_cvt_pk_bf16_f32 v135, v38, v39
    v_lshlrev_b32 v32, 16, v136
    v_and_b32 v33, 0xffff0000, v136
    v_lshlrev_b32 v34, 16, v137
    v_and_b32 v35, 0xffff0000, v137
    v_lshlrev_b32 v36, 16, v138
    v_and_b32 v37, 0xffff0000, v138
    v_lshlrev_b32 v38, 16, v139
    v_and_b32 v39, 0xffff0000, v139
    v_cvt_pk_bf16_f32 v136, v40, v41
    v_cvt_pk_bf16_f32 v137, v42, v43
    v_cvt_pk_bf16_f32 v138, v44, v45
    v_cvt_pk_bf16_f32 v139, v46, v47
    v_lshlrev_b32 v40, 16, v140
    v_and_b32 v41, 0xffff0000, v140
    v_lshlrev_b32 v42, 16, v141
    v_and_b32 v43, 0xffff0000, v141
    v_lshlrev_b32 v44, 16, v142
    v_and_b32 v45, 0xffff0000, v142
    v_lshlrev_b32 v46, 16, v143
    v_and_b32 v47, 0xffff0000, v143
    v_cvt_pk_bf16_f32 v140, v48, v49
    v_cvt_pk_bf16_f32 v141, v50, v51
    v_cvt_pk_bf16_f32 v142, v52, v53
    v_cvt_pk_bf16_f32 v143, v54, v55
    v_lshlrev_b32 v48, 16, v144
    v_and_b32 v49, 0xffff0000, v144
    v_lshlrev_b32 v50, 16, v145
    v_and_b32 v51, 0xffff0000, v145
    v_lshlrev_b32 v52, 16, v146
    v_and_b32 v53, 0xffff0000, v146
    v_lshlrev_b32 v54, 16, v147
    v_and_b32 v55, 0xffff0000, v147
    v_cvt_pk_bf16_f32 v144, v56, v57
    v_cvt_pk_bf16_f32 v145, v58, v59
    v_cvt_pk_bf16_f32 v146, v60, v61
    v_cvt_pk_bf16_f32 v147, v62, v63
    v_lshlrev_b32 v56, 16, v148
    v_and_b32 v57, 0xffff0000, v148
    v_lshlrev_b32 v58, 16, v149
    v_and_b32 v59, 0xffff0000, v149
    v_lshlrev_b32 v60, 16, v150
    v_and_b32 v61, 0xffff0000, v150
    v_lshlrev_b32 v62, 16, v151
    v_and_b32 v63, 0xffff0000, v151
    v_cvt_pk_bf16_f32 v148, v64, v65
    v_cvt_pk_bf16_f32 v149, v66, v67
    v_cvt_pk_bf16_f32 v150, v68, v69
    v_cvt_pk_bf16_f32 v151, v70, v71
    v_lshlrev_b32 v64, 16, v152
    v_and_b32 v65, 0xffff0000, v152
    v_lshlrev_b32 v66, 16, v153
    v_and_b32 v67, 0xffff0000, v153
    v_lshlrev_b32 v68, 16, v154
    v_and_b32 v69, 0xffff0000, v154
    v_lshlrev_b32 v70, 16, v155
    v_and_b32 v71, 0xffff0000, v155
    v_cvt_pk_bf16_f32 v152, v72, v73
    v_cvt_pk_bf16_f32 v153, v74, v75
    v_cvt_pk_bf16_f32 v154, v76, v77
    v_cvt_pk_bf16_f32 v155, v78, v79
    v_lshlrev_b32 v72, 16, v156
    v_and_b32 v73, 0xffff0000, v156
    v_lshlrev_b32 v74, 16, v157
    v_and_b32 v75, 0xffff0000, v157
    v_lshlrev_b32 v76, 16, v158
    v_and_b32 v77, 0xffff0000, v158
    v_lshlrev_b32 v78, 16, v159
    v_and_b32 v79, 0xffff0000, v159
    v_cvt_pk_bf16_f32 v156, v80, v81
    v_cvt_pk_bf16_f32 v157, v82, v83
    v_cvt_pk_bf16_f32 v158, v84, v85
    v_cvt_pk_bf16_f32 v159, v86, v87
    v_lshlrev_b32 v80, 16, v160
    v_and_b32 v81, 0xffff0000, v160
    v_lshlrev_b32 v82, 16, v161
    v_and_b32 v83, 0xffff0000, v161
    v_lshlrev_b32 v84, 16, v162
    v_and_b32 v85, 0xffff0000, v162
    v_lshlrev_b32 v86, 16, v163
    v_and_b32 v87, 0xffff0000, v163
    v_cvt_pk_bf16_f32 v160, v88, v89
    v_cvt_pk_bf16_f32 v161, v90, v91
    v_cvt_pk_bf16_f32 v162, v92, v93
    v_cvt_pk_bf16_f32 v163, v94, v95
    v_lshlrev_b32 v88, 16, v164
    v_and_b32 v89, 0xffff0000, v164
    v_lshlrev_b32 v90, 16, v165
    v_and_b32 v91, 0xffff0000, v165
    v_lshlrev_b32 v92, 16, v166
    v_and_b32 v93, 0xffff0000, v166
    v_lshlrev_b32 v94, 16, v167
    v_and_b32 v95, 0xffff0000, v167
    v_cvt_pk_bf16_f32 v164, v96, v97
    v_cvt_pk_bf16_f32 v165, v98, v99
    v_cvt_pk_bf16_f32 v166, v100, v101
    v_cvt_pk_bf16_f32 v167, v102, v103
    v_lshlrev_b32 v96, 16, v168
    v_and_b32 v97, 0xffff0000, v168
    v_lshlrev_b32 v98, 16, v169
    v_and_b32 v99, 0xffff0000, v169
    v_lshlrev_b32 v100, 16, v170
    v_and_b32 v101, 0xffff0000, v170
    v_lshlrev_b32 v102, 16, v171
    v_and_b32 v103, 0xffff0000, v171
    v_cvt_pk_bf16_f32 v168, v104, v105
    v_cvt_pk_bf16_f32 v169, v106, v107
    v_cvt_pk_bf16_f32 v170, v108, v109
    v_cvt_pk_bf16_f32 v171, v110, v111
    v_lshlrev_b32 v104, 16, v172
    v_and_b32 v105, 0xffff0000, v172
    v_lshlrev_b32 v106, 16, v173
    v_and_b32 v107, 0xffff0000, v173
    v_lshlrev_b32 v108, 16, v174
    v_and_b32 v109, 0xffff0000, v174
    v_lshlrev_b32 v110, 16, v175
    v_and_b32 v111, 0xffff0000, v175
    v_cvt_pk_bf16_f32 v172, v112, v113
    v_cvt_pk_bf16_f32 v173, v114, v115
    v_cvt_pk_bf16_f32 v174, v116, v117
    v_cvt_pk_bf16_f32 v175, v118, v119
    v_lshlrev_b32 v112, 16, v176
    v_and_b32 v113, 0xffff0000, v176
    v_lshlrev_b32 v114, 16, v177
    v_and_b32 v115, 0xffff0000, v177
    v_lshlrev_b32 v116, 16, v178
    v_and_b32 v117, 0xffff0000, v178
    v_lshlrev_b32 v118, 16, v179
    v_and_b32 v119, 0xffff0000, v179
    s_branch P_swapr
P_sw1st:
    v_cvt_pk_bf16_f32 v120, v0, v1
    v_cvt_pk_bf16_f32 v121, v2, v3
    v_cvt_pk_bf16_f32 v122, v4, v5
    v_cvt_pk_bf16_f32 v123, v6, v7
    v_cvt_pk_bf16_f32 v124, v8, v9
    v_cvt_pk_bf16_f32 v125, v10, v11
    v_cvt_pk_bf16_f32 v126, v12, v13
    v_cvt_pk_bf16_f32 v127, v14, v15
    v_cvt_pk_bf16_f32 v128, v16, v17
    v_cvt_pk_bf16_f32 v129, v18, v19
    v_cvt_pk_bf16_f32 v130, v20, v21
    v_cvt_pk_bf16_f32 v131, v22, v23
    v_cvt_pk_bf16_f32 v132, v24, v25
    v_cvt_pk_bf16_f32 v133, v26, v27
    v_cvt_pk_bf16_f32 v134, v28, v29
    v_cvt_pk_bf16_f32 v135, v30, v31
    v_cvt_pk_bf16_f32 v136, v32, v33
    v_cvt_pk_bf16_f32 v137, v34, v35
    v_cvt_pk_bf16_f32 v138, v36, v37
    v_cvt_pk_bf16_f32 v139, v38, v39
    v_cvt_pk_bf16_f32 v140, v40, v41
    v_cvt_pk_bf16_f32 v141, v42, v43
    v_cvt_pk_bf16_f32 v142, v44, v45
    v_cvt_pk_bf16_f32 v143, v46, v47
    v_cvt_pk_bf16_f32 v144, v48, v49
    v_cvt_pk_bf16_f32 v145, v50, v51
    v_cvt_pk_bf16_f32 v146, v52, v53
    v_cvt_pk_bf16_f32 v147, v54, v55
    v_cvt_pk_bf16_f32 v148, v56, v57
    v_cvt_pk_bf16_f32 v149, v58, v59
    v_cvt_pk_bf16_f32 v150, v60, v61
    v_cvt_pk_bf16_f32 v151, v62, v63
    v_cvt_pk_bf16_f32 v152, v64, v65
    v_cvt_pk_bf16_f32 v153, v66, v67
    v_cvt_pk_bf16_f32 v154, v68, v69
    v_cvt_pk_bf16_f32 v155, v70, v71
    v_cvt_pk_bf16_f32 v156, v72, v73
    v_cvt_pk_bf16_f32 v157, v74, v75
    v_cvt_pk_bf16_f32 v158, v76, v77
    v_cvt_pk_bf16_f32 v159, v78, v79
    v_cvt_pk_bf16_f32 v160, v80, v81
    v_cvt_pk_bf16_f32 v161, v82, v83
    v_cvt_pk_bf16_f32 v162, v84, v85
    v_cvt_pk_bf16_f32 v163, v86, v87
    v_cvt_pk_bf16_f32 v164, v88, v89
    v_cvt_pk_bf16_f32 v165, v90, v91
    v_cvt_pk_bf16_f32 v166, v92, v93
    v_cvt_pk_bf16_f32 v167, v94, v95
    v_cvt_pk_bf16_f32 v168, v96, v97
    v_cvt_pk_bf16_f32 v169, v98, v99
    v_cvt_pk_bf16_f32 v170, v100, v101
    v_cvt_pk_bf16_f32 v171, v102, v103
    v_cvt_pk_bf16_f32 v172, v104, v105
    v_cvt_pk_bf16_f32 v173, v106, v107
    v_cvt_pk_bf16_f32 v174, v108, v109
    v_cvt_pk_bf16_f32 v175, v110, v111
    v_cvt_pk_bf16_f32 v176, v112, v113
    v_cvt_pk_bf16_f32 v177, v114, v115
    v_cvt_pk_bf16_f32 v178, v116, v117
    v_cvt_pk_bf16_f32 v179, v118, v119
    v_mov_b32 v116, 0
    v_mov_b32 v117, 0
    v_mov_b32 v118, 0
    v_mov_b32 v119, 0
    s_nop 1
    v_mfma_f32_32x32x16_bf16 v[0:15], v[116:119], v[116:119], 0
    v_mfma_f32_32x32x16_bf16 v[16:31], v[116:119], v[116:119], 0
    v_mfma_f32_32x32x16_bf16 v[32:47], v[116:119], v[116:119], 0
    v_mfma_f32_32x32x16_bf16 v[48:63], v[116:119], v[116:119], 0
    v_mfma_f32_32x32x16_bf16 v[64:79], v[116:119], v[116:119], 0
    v_mfma_f32_32x32x16_bf16 v[80:95], v[116:119], v[116:119], 0
    v_mfma_f32_32x32x16_bf16 v[96:111], v[116:119], v[116:119], 0
    v_mfma_f32_16x16x32_bf16 v[112:115], v[116:119], v[116:119], 0
    s_branch P_swapr
L_end:
    s_endpgm
.p2align 8
.type L_table,@object
L_table:
    .long 0x100a001, 0x100a001, 0x100a001, 0x100a001, 0x100a001, 0x100a001, 0x100a001, 0x100a001
    .long 0x3a024, 0x15a00c, 0xa4a02d, 0xa02d, 0x90a02d, 0x20a02d, 0xa02d, 0x10a02d
    .long 0x20a02d, 0xa02d, 0x10a02d, 0x20a00d, 0x80a02d, 0x90a02d, 0x20a02d, 0x80a02d
    .long 0x10a02d, 0x20a02c, 0xa02d, 0x10a12d, 0x20a02d, 0xa02d, 0x10a02d, 0xa0a02d
    .long 0x80a02d, 0x10a02d, 0xa0a02d, 0xa00d, 0x10a04d, 0x20a00d, 0xa00d, 0x10a04d
    .long 0x20a00d, 0xa00c, 0x14a04e, 0x20a00e, 0xa00e, 0x14a04e, 0x25a00e, 0x5a00e
    .long 0x14a04e, 0x25a00e, 0xa00e, 0x14a04e, 0x25a00e, 0x5a40e, 0x1014a44e, 0x25a00e
    .long 0x5a00e, 0x2014a44e, 0x25a00e, 0x5a00e, 0x10a04e, 0x25a00e, 0x5a00e, 0x14a04e
    .long 0x25a00e, 0xa00e, 0x14a44e, 0x1025a40e, 0x2004a44e, 0x3014a44e, 0x4024a44e, 0x5004a44e
    .long 0x13a04a, 0x8002, 0x22002, 0x200a002, 0x200a002, 0x200a002, 0x200a002, 0x200a002
    .long 0x200a002, 0x200a002, 0x200a002, 0x200a002, 0x200a002, 0x200a002, 0x200a002, 0x200a002
    .long 0x200a002, 0x200a002, 0x1a000, 0x3000000, 0x0, 0x0, 0x0, 0x0
    .long 0x0, 0x0, 0x0, 0x0, 0x0, 0x0, 0x0, 0x0
    .long 0x0, 0x0, 0x0, 0x0, 0x0, 0x0, 0x0, 0x0
    .long 0x0, 0x0, 0x0, 0x0, 0x0, 0x0, 0x0, 0x0
    .long 0x0, 0x0, 0x0, 0x0, 0x0, 0x0, 0x0, 0x0
    .long 0x180000, 0x240000, 0x300000, 0x3c0000, 0x480000, 0x540000, 0x600000, 0x6c0000
    .long 0x0, 0x0, 0x6c0300, 0x300, 0xc0300, 0x180300, 0x240300, 0x300300
    .long 0x3c0300, 0x480300, 0x540300, 0x600300, 0x540600, 0x600600, 0x600, 0xc0600
    .long 0x180600, 0x0, 0x240600, 0x300600, 0x3c0600, 0x480600, 0x6c0600, 0x480900
    .long 0x6c0900, 0x900, 0xc0900, 0x180900, 0x240900, 0x300900, 0x3c0900, 0x540900
    .long 0x600900, 0x0, 0x78000, 0x82000, 0x8c000, 0x96000, 0xa0000, 0xaa000
    .long 0x78280, 0x82280, 0x8c280, 0x96280, 0xa0280, 0xaa280, 0x280, 0xa280
    .long 0x14280, 0xf0280, 0xfa280, 0x104280, 0x10e280, 0x118280, 0x122280, 0xf0000
    .long 0xfa000, 0x104000, 0x10e000, 0x118000, 0x122000, 0x0, 0xa000, 0x14000
    .long 0x1e000, 0x28000, 0x32000, 0x168000, 0x172000, 0x17c000, 0x186000, 0x190000
    .long 0x19a000, 0x1e280, 0x28280, 0x32280, 0x168280, 0x172280, 0x17c280, 0x186280
    .long 0x190280, 0x19a280, 0x0, 0x0, 0x0, 0x0, 0x0, 0x0
    .long 0x0, 0x0, 0x0, 0x0, 0x0, 0x0, 0x0, 0x0
    .long 0x0, 0x0, 0x0, 0x0, 0x0, 0x0, 0x0, 0x0
    .long 0x0, 0x0, 0x0, 0x0, 0x0, 0x0, 0x0, 0x0
    .long 0x0, 0x0, 0x0, 0x0, 0x0, 0x0, 0x0, 0x0
    .long 0x100, 0x180, 0x200, 0x280, 0x300, 0x380, 0x400, 0x480
    .long 0x0, 0x0, 0x480, 0x0, 0x80, 0x100, 0x180, 0x200
    .long 0x280, 0x300, 0x380, 0x400, 0x380, 0x400, 0x0, 0x80
    .long 0x100, 0x0, 0x180, 0x200, 0x280, 0x300, 0x480, 0x300
    .long 0x480, 0x0, 0x80, 0x100, 0x180, 0x200, 0x280, 0x380
    .long 0x400, 0x0, 0x0, 0x0, 0x0, 0x0, 0x0, 0x0
    .long 0x0, 0x0, 0x0, 0x0, 0x0, 0x25000, 0x26800, 0x0
    .long 0x0, 0x25000, 0x0, 0x0, 0x0, 0x0, 0x0, 0x0
    .long 0x0, 0x0, 0x12000, 0x13800, 0x15000, 0x16800, 0x18000, 0x19800
    .long 0x0, 0x0, 0x0, 0x0, 0x0, 0x0, 0x0, 0x0
    .long 0x0, 0x0, 0x0, 0x0, 0x0, 0x0, 0x0, 0x0
    .long 0x0, 0x0, 0x0, 0x0, 0x0, 0x0, 0x0, 0x0
    .long 0x0, 0x0, 0x0, 0x0, 0x0, 0x0, 0x0, 0x0
    .long 0x0, 0x0, 0x0, 0x0, 0x0, 0x0, 0x0, 0x0
    .long 0x0, 0x0, 0x0, 0x0, 0x0, 0x0, 0x0, 0x0
    .long 0x0, 0x0, 0x0, 0x0, 0x0, 0x0, 0x0, 0x0
    .long 0x9000, 0x1b000, 0x12000, 0x9000, 0x1b000, 0x12000, 0x9000, 0x1b000
    .long 0x0, 0x0, 0x1b000, 0x12000, 0x1b000, 0x12000, 0x1b000, 0x12000
    .long 0x1b000, 0x12000, 0x1b000, 0x12000, 0x1b000, 0x12000, 0x1b000, 0x12000
    .long 0x1b000, 0x0, 0x1b000, 0x12000, 0x1b000, 0x12000, 0x1b000, 0x12000
    .long 0x1b000, 0x12000, 0x1b000, 0x12000, 0x1b000, 0x12000, 0x1b000, 0x12000
    .long 0x1b000, 0x0, 0x1b000, 0x20000, 0x1b000, 0x20000, 0x1b000, 0x20000
    .long 0x1b000, 0x20000, 0x1b000, 0x20000, 0x1b000, 0x20000, 0x1b000, 0x20000
    .long 0x1b000, 0x20000, 0x1b000, 0x20000, 0x1b000, 0x20000, 0x1b000, 0x20000
    .long 0x1b000, 0x20000, 0x1b000, 0x20000, 0x1b000, 0x20000, 0x1b000, 0x20000
    .long 0x1b000, 0x20000, 0xc000, 0x1b000, 0x20000, 0xc000, 0x1b000, 0x20000
    .long 0xc000, 0x1b000, 0x20000, 0xc000, 0x1b000, 0x20000, 0xc000, 0x1b000
    .long 0x11000, 0x16000, 0x0, 0x0, 0x0, 0x0, 0x0, 0x0
    .long 0x0, 0x0, 0x0, 0x0, 0x0, 0x0, 0x0, 0x0
    .long 0x0, 0x0, 0x0, 0x0, 0x0, 0x0, 0x0, 0x0
    .long 0x0, 0x0, 0x0, 0x0, 0x0, 0x0, 0x0, 0x0
    .long 0x0, 0x0, 0x0, 0x0, 0x0, 0x0, 0x0, 0x0
    .long 0x0, 0x0, 0x0, 0x0, 0x0, 0x0, 0x0, 0x0
    .long 0x0, 0x3000, 0x6000, 0x9000, 0xc000, 0xf000, 0x12000, 0x15000
    .long 0x18000, 0x1b000, 0x1e000, 0x21000, 0x24000, 0x27000, 0x2a000, 0x2d000
    .long 0x60000, 0x63000, 0x66000, 0x69000, 0x6c000, 0x6f000, 0x72000, 0x75000
    .long 0x78000, 0x7b000, 0x7e000, 0x81000, 0x84000, 0x87000, 0x8a000, 0x8d000
    .long 0xc0000, 0xc3000, 0xc6000, 0xc9000, 0xcc000, 0xcf000, 0xd2000, 0xd5000
    .long 0xd8000, 0xdb000, 0xde000, 0xe1000, 0xe4000, 0xe7000, 0xea000, 0xed000
    .long 0x120000, 0x123000, 0x126000, 0x129000, 0x12c000, 0x12f000, 0x132000, 0x135000
    .long 0x138000, 0x13b000, 0x13e000, 0x141000, 0x144000, 0x147000, 0x14a000, 0x14d000
    .long 0x0, 0x0, 0x0, 0x0, 0x0, 0x0, 0x0, 0x0
    .long 0x0, 0x0, 0x0, 0x0, 0x0, 0x0, 0x0, 0x0
    .long 0x0, 0x0, 0x0, 0x0, 0x0, 0x0, 0x0, 0x0
    .long 0x0, 0x0, 0x0, 0x0, 0x0, 0x0, 0x0, 0x0
    .long 0x0, 0x0, 0x0, 0x0, 0x0, 0x0, 0x0, 0x0
    .long 0x0, 0x0, 0x0, 0x0, 0x0, 0x0, 0x0, 0x0
    .long 0x0, 0x0, 0x0, 0x0, 0x0, 0x0, 0x0, 0x0
    .long 0x0, 0x0, 0x0, 0x0, 0x0, 0x0, 0x0, 0x0
    .long 0x0, 0x0, 0x3000, 0x6000, 0x9000, 0xc000, 0xf000, 0x12000
    .long 0x15000, 0x18000, 0x1b000, 0x1e000, 0x21000, 0x24000, 0x27000, 0x2a000
    .long 0x2d000, 0x60000, 0x63000, 0x66000, 0x69000, 0x6c000, 0x6f000, 0x72000
    .long 0x75000, 0x78000, 0x7b000, 0x7e000, 0x81000, 0x84000, 0x87000, 0x8a000
    .long 0x8d000, 0xc0000, 0xc3000, 0xc6000, 0xc9000, 0xcc000, 0xcf000, 0xd2000
    .long 0xd5000, 0xd8000, 0xdb000, 0xde000, 0xe1000, 0xe4000, 0xe7000, 0xea000
    .long 0xed000, 0x120000, 0x123000, 0x126000, 0x129000, 0x12c000, 0x12f000, 0x132000
    .long 0x135000, 0x138000, 0x13b000, 0x13e000, 0x141000, 0x144000, 0x147000, 0x14a000
    .long 0x14d000, 0x0, 0x0, 0x0, 0x0, 0x0, 0x0, 0x0
    .long 0x0, 0x0, 0x0, 0x0, 0x0, 0x0, 0x0, 0x0
    .long 0x0, 0x0, 0x0, 0x0, 0x0, 0x0, 0x0, 0x0
    .long 0x0, 0x0, 0x0, 0x0, 0x0, 0x0, 0x0, 0x0
    .long 0x0, 0x0, 0x0, 0x0, 0x0, 0x0, 0x0, 0x0
    .long 0x0, 0x0, 0x0, 0x0, 0x0, 0x0, 0x0, 0x0
    .long 0x0, 0x0, 0x0, 0x0, 0x0, 0x0, 0x0, 0x0
    .long 0x0, 0x0, 0x0, 0x0, 0x0, 0x0, 0x0, 0x0
    .long 0x0, 0x0, 0x0, 0x0, 0x0, 0x0, 0x0, 0x0
    .long 0x0, 0x0, 0x0, 0x0, 0x0, 0x0, 0x0, 0x0
    .long 0x0, 0x0, 0x0, 0x0, 0x0, 0x0, 0x0, 0x0
    .long 0x0, 0x0, 0x0, 0x0, 0x0, 0x0, 0x0, 0x0
    .long 0x0, 0x0, 0x0, 0x0, 0x0, 0x0, 0x0, 0x0
    .long 0x0, 0x0, 0x0, 0x0, 0x0, 0x0, 0x0, 0x0
    .long 0x0, 0x0, 0x0, 0x0, 0x0, 0x0, 0x0, 0x0
    .long 0x0, 0x0, 0x0, 0x0, 0x0, 0x0, 0x0, 0x0
    .long 0x0, 0x0, 0x0, 0x0, 0x0, 0x0, 0x0, 0x0
    .long 0x0, 0x0, 0x0, 0x0, 0x0, 0x0, 0x0, 0x0
    .long 0x0, 0x0, 0x0, 0x0, 0x0, 0x0, 0x0, 0x0
    .long 0x0, 0x0, 0x0, 0x0, 0x0, 0x0, 0x0, 0x0
    .long 0x0, 0x0, 0x0, 0x0, 0x0, 0x0, 0x0, 0x0
    .long 0x0, 0x0, 0x0, 0x0, 0x0, 0x0, 0x0, 0x0
    .long 0x0, 0x0, 0x0, 0x0, 0x0, 0x0, 0x0, 0x0
    .long 0x0, 0x0, 0x0, 0x0, 0x0, 0x0, 0x0, 0x0
    .long 0x6c0300, 0x0, 0x3c0300, 0x480300, 0x540300, 0x600300, 0x540600, 0x600600
    .long 0x600, 0xc0600, 0x180600, 0x0, 0x240600, 0x300600, 0x3c0600, 0x480600
    .long 0x6c0600, 0x480900, 0x6c0900, 0x900, 0xc0900, 0x180900, 0x240900, 0x300900
    .long 0x3c0900, 0x540900, 0x600900, 0x0, 0x0, 0x0, 0x0, 0x0
    .long 0x0, 0x0, 0x0, 0x0, 0x0, 0x0, 0x0, 0x0
    .long 0x0, 0x0, 0x0, 0x0, 0x0, 0x0, 0x0, 0x0
    .long 0x0, 0x0, 0x0, 0x0, 0x0, 0x0, 0x0, 0x0
    .long 0x0, 0x0, 0x0, 0x0, 0x0, 0x0, 0x0, 0x0
    .long 0x0, 0x0, 0x0, 0x0, 0x0, 0x0, 0x0, 0x0
    .long 0x0, 0x0, 0x0, 0x0, 0x0, 0x0, 0x0, 0x0
    .long 0x0, 0x0, 0x0, 0x0, 0x0, 0x0, 0x0, 0x0
    .long 0x0, 0x0, 0x0, 0x0, 0x0, 0x0, 0x0, 0x0
    .long 0x0, 0x0, 0x0, 0x0, 0x0, 0x0, 0x0, 0x0
    .long 0x0, 0x0, 0x0, 0x0, 0x0, 0x0, 0x0, 0x0
    .long 0x0, 0x0, 0x0, 0x0, 0x0, 0x0, 0x0, 0x0
    .long 0x0, 0x0, 0x0, 0x0, 0x0, 0x0, 0x0, 0x0
    .long 0x0, 0x0, 0x0, 0x0, 0x0, 0x0, 0x0, 0x0
    .long 0x0, 0x0, 0x0, 0x0, 0x0, 0x0, 0x0, 0x0
    .long 0x0, 0x0, 0x0, 0x0, 0x0, 0x0, 0x0, 0x0
    .long 0x0, 0x0, 0x0, 0x0, 0x78000, 0x0, 0x0, 0x96000
    .long 0x0, 0x0, 0x78280, 0x0, 0x0, 0x96280, 0x0, 0x0
    .long 0x280, 0x0, 0x0, 0xf0280, 0x0, 0x0, 0x10e280, 0x0
    .long 0x0, 0xf0000, 0x0, 0x0, 0x10e000, 0x0, 0x0, 0x0
    .long 0x0, 0x0, 0x1e000, 0x0, 0x168000, 0x186000, 0x1e280, 0x168280
    .long 0x186280, 0x0, 0x0, 0x0, 0x0, 0x0, 0x0, 0x0
    .long 0x0, 0x0, 0x0, 0x0, 0x0, 0x0, 0x0, 0x0
    .long 0x0, 0x0, 0x0, 0x0, 0x0, 0x0, 0x0, 0x0
    .long 0x0, 0x0, 0x0, 0x0, 0x0, 0x0, 0x0, 0x0
    .long 0x0, 0x0, 0x0, 0x0, 0x0, 0x0, 0x0, 0x0
    .long 0x0, 0x0, 0x0, 0x0, 0x0, 0x0, 0x0, 0x0
    .long 0x0, 0x0, 0x0, 0x0, 0x0, 0x0, 0x0, 0x0
    .long 0x6770208, 0xd6770029, 0x24120029, 0xee770029, 0xee770029, 0x24120029, 0xee770029, 0xee770029
    .long 0x24120029, 0xee77002c, 0x12090000, 0xee770208, 0x18090029, 0xe8770029, 0x12090029, 0xee770029
    .long 0x12090029, 0xee770029, 0x12090029, 0xee770029, 0x12090029, 0xee7702a8, 0x12090029, 0x6770029
    .long 0xfa090029, 0xee77012d, 0x12090020, 0xee770008, 0x12090029, 0xee770029, 0x12090029, 0xee770029
    .long 0x120902a8, 0xee770029, 0x18090029, 0xe8770029, 0x12090029, 0xee770029, 0x12090029, 0xee770029
    .long 0x12090029, 0xee77012d, 0x904a0, 0x50010, 0x37b0052, 0x3050052, 0x37b0052, 0x3050052
    .long 0x37b0052, 0xf1051250, 0x37b0052, 0x3050052, 0x37b0052, 0x3050052, 0x37b0052, 0x17050052
    .long 0x37b0052, 0xfd050150, 0xda7b0850, 0x3050850, 0x37b0052, 0x3050052, 0x37b0052, 0x3050052
    .long 0xf17b1050, 0x3050052, 0x37b0052, 0x3050052, 0x37b0052, 0x3050052, 0xf17b0052, 0x3050052
    .long 0x37b0052, 0x3050052, 0x36c0052, 0x30f0053, 0xcd050052, 0x36c0052, 0x30f0052, 0x3050052
    .long 0x36c0052, 0x30f0052, 0x1e053050, 0x36c0052, 0x30f0052, 0xcd050052, 0x36c0052, 0x30f0052
    .long 0x3760052, 0x3050052, 0x3000052, 0x43, 0x0, 0x0, 0x0, 0x0
    .long 0x0, 0x0, 0x0, 0x0, 0x0, 0x0, 0x0, 0x0
    .long 0x0, 0x0, 0x0, 0x0, 0x0, 0x0, 0x0, 0x0
    .long 0x0, 0x0, 0x0, 0x0, 0x0, 0x0, 0x0, 0x0
    .long 0x0, 0x0, 0x0, 0x0, 0x0, 0x0, 0x0, 0x0
L_tabend:
.size L_table, 5120

.globl reduce_kernel
.p2align 8
.type reduce_kernel,@function
reduce_kernel:
    s_load_dwordx2 s[4:5], s[0:1], 96
    s_load_dwordx2 s[8:9], s[0:1], 80
    s_cmp_ge_u32 s2, 768
    s_cbranch_scc1 R_end
    v_lshrrev_b32 v1, 6, v0
    v_and_b32 v0, 63, v0
    s_and_b32 s12, s2, 7
    v_readfirstlane_b32 s3, v1
    s_mul_i32 s12, s12, 24
    s_lshr_b32 s13, s2, 5
    s_add_u32 s12, s12, s13
    s_mul_i32 s13, s12, 171
    s_lshr_b32 s13, s13, 9
    s_mul_i32 s14, s13, 3
    s_sub_u32 s14, s12, s14
    s_cmp_ge_u32 s3, 5
    s_cselect_b32 s15, 1, 0
    s_cselect_b32 s16, 5, 0
    s_sub_u32 s16, s3, s16
    s_bfe_u32 s17, s2, 0x20003
    s_lshl_b32 s17, s17, 0
    s_add_u32 s15, s15, s17
    s_mul_i32 s17, s14, 5
    s_add_u32 s17, s17, s16
    s_lshl_b32 s17, s17, 13
    s_mul_i32 s18, s13, 557056
    s_add_u32 s18, s18, s17
    s_mul_i32 s17, s15, 139264
    s_add_u32 s18, s18, s17
    s_add_u32 s18, s18, 38797312
    s_mov_b32 s6, 438042624
    s_mov_b32 s7, 0x20000
    v_lshlrev_b32 v2, 4, v0
    s_waitcnt lgkmcnt(0)
    buffer_load_dwordx4 v[8:11], v2, s[4:7], s18 offen offset:0 nt
    buffer_load_dwordx4 v[12:15], v2, s[4:7], s18 offen offset:1024 nt
    buffer_load_dwordx4 v[16:19], v2, s[4:7], s18 offen offset:2048 nt
    buffer_load_dwordx4 v[20:23], v2, s[4:7], s18 offen offset:3072 nt
    s_add_u32 s18, s18, 4096
    buffer_load_dwordx4 v[24:27], v2, s[4:7], s18 offen offset:0 nt
    buffer_load_dwordx4 v[28:31], v2, s[4:7], s18 offen offset:1024 nt
    buffer_load_dwordx4 v[32:35], v2, s[4:7], s18 offen offset:2048 nt
    buffer_load_dwordx4 v[36:39], v2, s[4:7], s18 offen offset:3072 nt
    s_mov_b32 s10, 3932160
    s_mov_b32 s11, 0x20000
    v_and_b32 v3, 15, v0
    v_mul_u32_u24 v3, 2560, v3
    v_lshrrev_b32 v4, 4, v0
    v_lshl_add_u32 v3, v4, 3, v3
    s_bfe_u32 s20, s13, 0x40001
    s_mul_i32 s20, s20, 245760
    s_lshr_b32 s21, s13, 5
    s_mul_i32 s21, s21, 1280
    s_add_u32 s20, s20, s21
    s_and_b32 s21, s13, 1
    s_mul_i32 s21, s21, 640
    s_add_u32 s20, s20, s21
    s_mul_i32 s21, s15, 160
    s_add_u32 s20, s20, s21
    s_mul_i32 s21, s14, 81920
    s_add_u32 s20, s20, s21
    s_lshl_b32 s16, s16, 1
    s_cmp_ge_u32 s16, 5
    s_cselect_b32 s22, 40800, 0
    s_lshl_b32 s23, s16, 5
    s_add_u32 s22, s22, s23
    s_add_u32 s24, s22, s20
    s_add_u32 s16, s16, 1
    s_cmp_ge_u32 s16, 5
    s_cselect_b32 s22, 40800, 0
    s_lshl_b32 s23, s16, 5
    s_add_u32 s22, s22, s23
    s_add_u32 s25, s22, s20
    s_add_u32 s16, s16, 1
    s_sub_u32 s25, s25, s24
    v_and_b32 v3, 15, v0
    v_mul_u32_u24 v3, 2560, v3
    v_lshrrev_b32 v5, 1, v4
    v_lshl_add_u32 v3, v5, 4, v3
    v_and_b32 v5, 1, v4
    v_mul_u32_u24 v5, s25, v5
    v_add_u32 v3, v3, v5
    s_waitcnt vmcnt(7)
    v_lshlrev_b32 v40, 16, v8
    v_and_b32 v41, 0xffff0000, v8
    v_lshlrev_b32 v42, 16, v9
    v_and_b32 v43, 0xffff0000, v9
    v_lshlrev_b32 v44, 16, v10
    v_and_b32 v45, 0xffff0000, v10
    v_lshlrev_b32 v46, 16, v11
    v_and_b32 v47, 0xffff0000, v11
    s_waitcnt vmcnt(6)
    v_lshlrev_b32 v48, 16, v12
    v_and_b32 v49, 0xffff0000, v12
    v_lshlrev_b32 v50, 16, v13
    v_and_b32 v51, 0xffff0000, v13
    v_lshlrev_b32 v52, 16, v14
    v_and_b32 v53, 0xffff0000, v14
    v_lshlrev_b32 v54, 16, v15
    v_and_b32 v55, 0xffff0000, v15
    v_pk_add_f32 v[40:41], v[40:41], v[48:49]
    v_pk_add_f32 v[42:43], v[42:43], v[50:51]
    v_pk_add_f32 v[44:45], v[44:45], v[52:53]
    v_pk_add_f32 v[46:47], v[46:47], v[54:55]
    s_waitcnt vmcnt(5)
    v_lshlrev_b32 v48, 16, v16
    v_and_b32 v49, 0xffff0000, v16
    v_lshlrev_b32 v50, 16, v17
    v_and_b32 v51, 0xffff0000, v17
    v_lshlrev_b32 v52, 16, v18
    v_and_b32 v53, 0xffff0000, v18
    v_lshlrev_b32 v54, 16, v19
    v_and_b32 v55, 0xffff0000, v19
    v_pk_add_f32 v[40:41], v[40:41], v[48:49]
    v_pk_add_f32 v[42:43], v[42:43], v[50:51]
    v_pk_add_f32 v[44:45], v[44:45], v[52:53]
    v_pk_add_f32 v[46:47], v[46:47], v[54:55]
    s_waitcnt vmcnt(4)
    v_lshlrev_b32 v48, 16, v20
    v_and_b32 v49, 0xffff0000, v20
    v_lshlrev_b32 v50, 16, v21
    v_and_b32 v51, 0xffff0000, v21
    v_lshlrev_b32 v52, 16, v22
    v_and_b32 v53, 0xffff0000, v22
    v_lshlrev_b32 v54, 16, v23
    v_and_b32 v55, 0xffff0000, v23
    v_pk_add_f32 v[40:41], v[40:41], v[48:49]
    v_pk_add_f32 v[42:43], v[42:43], v[50:51]
    v_pk_add_f32 v[44:45], v[44:45], v[52:53]
    v_pk_add_f32 v[46:47], v[46:47], v[54:55]
    s_waitcnt vmcnt(3)
    v_lshlrev_b32 v48, 16, v24
    v_and_b32 v49, 0xffff0000, v24
    v_lshlrev_b32 v50, 16, v25
    v_and_b32 v51, 0xffff0000, v25
    v_lshlrev_b32 v52, 16, v26
    v_and_b32 v53, 0xffff0000, v26
    v_lshlrev_b32 v54, 16, v27
    v_and_b32 v55, 0xffff0000, v27
    v_pk_add_f32 v[40:41], v[40:41], v[48:49]
    v_pk_add_f32 v[42:43], v[42:43], v[50:51]
    v_pk_add_f32 v[44:45], v[44:45], v[52:53]
    v_pk_add_f32 v[46:47], v[46:47], v[54:55]
    s_waitcnt vmcnt(2)
    v_lshlrev_b32 v48, 16, v28
    v_and_b32 v49, 0xffff0000, v28
    v_lshlrev_b32 v50, 16, v29
    v_and_b32 v51, 0xffff0000, v29
    v_lshlrev_b32 v52, 16, v30
    v_and_b32 v53, 0xffff0000, v30
    v_lshlrev_b32 v54, 16, v31
    v_and_b32 v55, 0xffff0000, v31
    v_pk_add_f32 v[40:41], v[40:41], v[48:49]
    v_pk_add_f32 v[42:43], v[42:43], v[50:51]
    v_pk_add_f32 v[44:45], v[44:45], v[52:53]
    v_pk_add_f32 v[46:47], v[46:47], v[54:55]
    s_waitcnt vmcnt(1)
    v_lshlrev_b32 v48, 16, v32
    v_and_b32 v49, 0xffff0000, v32
    v_lshlrev_b32 v50, 16, v33
    v_and_b32 v51, 0xffff0000, v33
    v_lshlrev_b32 v52, 16, v34
    v_and_b32 v53, 0xffff0000, v34
    v_lshlrev_b32 v54, 16, v35
    v_and_b32 v55, 0xffff0000, v35
    v_pk_add_f32 v[40:41], v[40:41], v[48:49]
    v_pk_add_f32 v[42:43], v[42:43], v[50:51]
    v_pk_add_f32 v[44:45], v[44:45], v[52:53]
    v_pk_add_f32 v[46:47], v[46:47], v[54:55]
    s_waitcnt vmcnt(0)
    v_lshlrev_b32 v48, 16, v36
    v_and_b32 v49, 0xffff0000, v36
    v_lshlrev_b32 v50, 16, v37
    v_and_b32 v51, 0xffff0000, v37
    v_lshlrev_b32 v52, 16, v38
    v_and_b32 v53, 0xffff0000, v38
    v_lshlrev_b32 v54, 16, v39
    v_and_b32 v55, 0xffff0000, v39
    v_pk_add_f32 v[40:41], v[40:41], v[48:49]
    v_pk_add_f32 v[42:43], v[42:43], v[50:51]
    v_pk_add_f32 v[44:45], v[44:45], v[52:53]
    v_pk_add_f32 v[46:47], v[46:47], v[54:55]
    v_cvt_pk_bf16_f32 v56, v40, v41
    v_cvt_pk_bf16_f32 v57, v42, v43
    v_cvt_pk_bf16_f32 v58, v44, v45
    v_cvt_pk_bf16_f32 v59, v46, v47
    s_nop 0
    v_permlane16_swap_b32 v56, v58
    s_nop 0
    v_permlane16_swap_b32 v57, v59
    buffer_store_dwordx4 v[56:59], v3, s[8:11], s24 offen
R_end:
    s_endpgm
L_codeend:

.section .rodata,"a"
.p2align 6
.amdhsa_kernel concat_heads__gqa_block_cached__gqa_block_cached__near_ridge_kernel
  .amdhsa_next_free_vgpr 256
  .amdhsa_next_free_sgpr 102
  .amdhsa_accum_offset 256
  .amdhsa_group_segment_fixed_size 0
  .amdhsa_kernarg_size 104
  .amdhsa_user_sgpr_count 2
  .amdhsa_user_sgpr_kernarg_segment_ptr 1
  .amdhsa_system_sgpr_workgroup_id_x 1
.end_amdhsa_kernel
.p2align 6
.amdhsa_kernel reduce_kernel
  .amdhsa_next_free_vgpr 64
  .amdhsa_next_free_sgpr 40
  .amdhsa_accum_offset 64
  .amdhsa_group_segment_fixed_size 0
  .amdhsa_kernarg_size 104
  .amdhsa_user_sgpr_count 2
  .amdhsa_user_sgpr_kernarg_segment_ptr 1
  .amdhsa_system_sgpr_workgroup_id_x 1
.end_amdhsa_kernel
```
